```python
import torch

def _softmax(x, axis=-1):
    return torch.softmax(x, dim=axis)

def _gelu(x):
    return torch.nn.functional.gelu(x, approximate='tanh')

def _silu(x):
    return torch.nn.functional.silu(x)

def _sigmoid(x):
    return torch.sigmoid(x)

def _layernorm(x, axis=-1, eps=1e-05):
    m = x.mean(dim=axis, keepdim=True)
    v = x.var(dim=axis, keepdim=True, unbiased=False)
    return (x - m) / torch.sqrt(v + eps)

def _scatter_add(tgt, idx, src, axis=0):
    return tgt.clone().index_add_(axis, idx, src)

def _segment_sum(src, seg, n):
    out = torch.zeros((n,) + src.shape[1:], dtype=src.dtype)
    return out.index_add_(0, seg, src)

def _pad(x, pw):
    flat = tuple((v for pair in reversed(pw) for v in pair))
    return torch.nn.functional.pad(x, flat)
kernel_name = 'adaLN_cond__spectral_gfnet__glu_gated_reglu__prompt'

def setup_inputs():

    _w = lambda a: (lambda t: t.to(torch.bfloat16) if t.is_floating_point() else t)(torch.as_tensor(a))

    def _A_setup():
        B, S, D = (1, 2048, 640)
        Df = D // 2 + 1
        return {'x': _w((lambda *s: torch.randn(*s, dtype=torch.bfloat16) * 0.05)(B, S, D)), 'w_r': _w((lambda *s: torch.randn(*s, dtype=torch.bfloat16) * 1.6)(S, Df) * 0.02), 'w_i': _w((lambda *s: torch.randn(*s, dtype=torch.bfloat16) * 1.6)(S, Df) * 0.02)}
    _A_in = _A_setup()

    def _B_setup():
        B, S, D, F = (1, 2048, 640, 1536)
        return {'x': _w((lambda *s: torch.randn(*s, dtype=torch.bfloat16) * 0.05)(B, S, D)), 'W_gate': _w((lambda *s: torch.randn(*s, dtype=torch.bfloat16) * 0.4)(D, F) * (2.0 / D) ** 0.5), 'W_up': _w((lambda *s: torch.randn(*s, dtype=torch.bfloat16) * 0.4)(D, F) * (2.0 / D) ** 0.5), 'W_down': _w((lambda *s: torch.randn(*s, dtype=torch.bfloat16) * 0.4)(F, D) * (1.0 / F) ** 0.5)}
    _B_in = _B_setup()
    return {'A_x': _A_in['x'], 'A_w_r': _A_in['w_r'], 'A_w_i': _A_in['w_i'], 'B_x': _B_in['x'], 'B_W_gate': _B_in['W_gate'], 'B_W_up': _B_in['W_up'], 'B_W_down': _B_in['W_down'], 'c': _w((lambda *s: torch.randn(*s, dtype=torch.bfloat16) * 0.2)(1, 640) * 8.0), 'w_mod': _w((lambda *s: torch.randn(*s, dtype=torch.bfloat16) * 0.2)(640, 6 * 640) * 640 ** (-0.5) * 8.0)}

def reference(A_x, A_w_r, A_w_i, B_x, B_W_gate, B_W_up, B_W_down, c, w_mod):

    def _A_ref(x, w_r, w_i):
        B, S, D = x.shape
        X = (lambda x, axes=(-2, -1): torch.fft.rfft2(x.float(), dim=axes))(x, axes=(-2, -1))
        W = w_r + 1j * w_i
        X = X * W
        y = (lambda x, s, axes=(-2, -1): torch.fft.irfft2(x, s=s, dim=axes).to(torch.bfloat16))(X, (S, D), axes=(-2, -1))
        return y

    def _B_ref(x, W_gate, W_up, W_down):
        gate = torch.einsum('bsd,df->bsf', x, W_gate)
        up = torch.einsum('bsd,df->bsf', x, W_up)
        gate = gate * (lambda x, dt: x.to(dt))(gate > 0, gate.dtype)
        h = gate * up
        return torch.einsum('bsf,fd->bsd', h, W_down)
    x = A_x
    mod = (_silu(c) @ w_mod).reshape(c.shape[0], 6, 1, -1)
    sa, ca, ga, sb, cb, gb = (mod[:, 0].clone(), mod[:, 1].clone(), mod[:, 2].clone(), mod[:, 3].clone(), mod[:, 4].clone(), mod[:, 5].clone())
    h = _layernorm(x, axis=-1) * (1 + ca) + sa
    x = x + ga * _A_ref(h, A_w_r, A_w_i)
    h = _layernorm(x, axis=-1) * (1 + cb) + sb
    x = x + gb * _B_ref(h, B_W_gate, B_W_up, B_W_down)
    return x
```

```asm
; @launch grid=(256,1,1) block=(256,1,1) lds=163840
.amdgcn_target "amdgcn-amd-amdhsa--gfx950"
.text
.globl adaLN_cond__spectral_gfnet__glu_gated_reglu__prompt_kernel
.p2align 8
.type adaLN_cond__spectral_gfnet__glu_gated_reglu__prompt_kernel,@function
adaLN_cond__spectral_gfnet__glu_gated_reglu__prompt_kernel:
    s_cmp_ge_u32 s2, 256
    s_cbranch_scc1 Lm_end
    s_load_dwordx2 s[56:57], s[0:1], 64
    s_load_dwordx2 s[20:21], s[0:1], 56
    s_load_dwordx2 s[24:25], s[0:1], 80
    s_load_dwordx2 s[4:5], s[0:1], 88
    s_load_dwordx2 s[40:41], s[0:1], 72
    s_load_dwordx2 s[42:43], s[0:1], 0
    s_load_dwordx2 s[44:45], s[0:1], 8
    s_load_dwordx2 s[48:49], s[0:1], 16
    s_load_dwordx4 s[52:55], s[0:1], 32
    s_load_dwordx2 s[6:7], s[0:1], 48
    s_memrealtime s[8:9]
    s_getpc_b64 s[28:29]
Lpc0:
    s_lshr_b32 s61, s2, 3
    s_cmp_eq_u32 s61, 1
    s_cselect_b32 s30, Lcode_end-Lpc0, 0
    s_mov_b32 s31, 0x20000
    v_lshlrev_b32 v188, 7, v0
    buffer_load_dword v255, v188, s[28:31], 0 offen
    v_and_b32 v1, 63, v0
    v_lshrrev_b32 v2, 6, v0
    s_nop 0
    v_readfirstlane_b32 s3, v2
    s_and_b32 s62, s2, 7
    s_mul_i32 s60, s62, 10
    s_add_u32 s60, s60, s61
    s_sub_u32 s60, s60, 2
    s_mul_i32 s35, s62, 20
    s_add_u32 s35, s35, s61
    s_add_u32 s35, s35, 68
    s_cmp_lt_u32 s61, 12
    s_cselect_b32 s60, s60, s35
    s_cmp_lt_u32 s61, 2
    s_cselect_b32 s60, 240, s60
    s_cselect_b32 s58, 0, 4915200
    s_mov_b32 s59, 0x20000
    s_movk_i32 s22, 1280
    s_mov_b32 s23, 0x20000
    s_mov_b32 s27, 0x20000
    v_lshrrev_b32 v240, 3, v0
    v_and_b32 v190, 7, v0
    v_mul_u32_u24 v251, 7680, v240
    v_lshl_add_u32 v251, v190, 4, v251
    v_lshlrev_b32 v240, 1, v240
    s_and_b32 s34, s60, 3
    s_mul_i32 s35, s34, 1228800
    s_lshr_b32 s32, s60, 2
    s_lshl_b32 s32, s32, 7
    s_add_u32 s35, s35, s32
    s_mul_i32 s39, s34, 320
    v_mov_b32 v188, 0
    s_or_b32 s32, s2, s3
    s_cmp_eq_u32 s32, 0
    s_cselect_b32 s26, 256, 0
    s_waitcnt lgkmcnt(0)
    s_bitset1_b32 s9, 31
    v_mov_b32 v186, s8
    v_mov_b32 v187, s9
    s_mov_b64 exec, 1
    buffer_store_dwordx2 v[186:187], v188, s[24:27], 0 offen sc1
    s_mov_b64 exec, -1
    buffer_load_ushort v244, v240, s[20:23], s39 offen offset:0
    buffer_load_ushort v245, v240, s[20:23], s39 offen offset:64
    buffer_load_ushort v246, v240, s[20:23], s39 offen offset:128
    buffer_load_ushort v247, v240, s[20:23], s39 offen offset:192
    buffer_load_ushort v248, v240, s[20:23], s39 offen offset:256
    buffer_load_dwordx4 v[160:163], v251, s[56:59], s35 offen
    s_add_u32 s35, s35, 245760
    buffer_load_dwordx4 v[164:167], v251, s[56:59], s35 offen
    s_add_u32 s35, s35, 245760
    buffer_load_dwordx4 v[168:171], v251, s[56:59], s35 offen
    s_add_u32 s35, s35, 245760
    buffer_load_dwordx4 v[172:175], v251, s[56:59], s35 offen
    s_add_u32 s35, s35, 245760
    buffer_load_dwordx4 v[176:179], v251, s[56:59], s35 offen
    v_lshlrev_b32 v2, 4, v1
    v_and_b32 v3, 31, v1
    v_lshrrev_b32 v4, 5, v1
    v_lshl_add_u32 v5, v3, 1, v4
    s_mov_b32 s13, 0xffff0000
    s_mov_b32 s33, 0x3f803f80
    s_lshl_b32 s14, s62, 5
    s_add_u32 s14, s14, s61
    s_mul_i32 s15, s62, 27
    s_min_u32 s32, s61, 26
    s_add_u32 s15, s15, s32
    s_cmp_lt_u32 s61, 27
    s_cselect_b32 s63, 0, 1073741824
    s_cmp_lt_u32 s15, 214
    s_cselect_b32 s63, s63, 1073741824
    s_min_u32 s15, s15, 213
    s_lshr_b32 s10, s62, 2
    s_lshl_b32 s10, s10, 3
    s_lshr_b32 s32, s61, 2
    s_add_u32 s10, s10, s32
    s_and_b32 s11, s62, 3
    s_lshl_b32 s11, s11, 2
    s_and_b32 s32, s61, 3
    s_add_u32 s11, s11, s32
    s_lshl_b32 s12, s10, 4
    s_add_u32 s12, s12, s11
    v_mov_b32 v71, 1073741824
    v_lshlrev_b32 v238, 4, v5
    s_lshl_b32 s32, s3, 5
    v_add_u32 v231, s32, v3
    v_cmp_ge_u32 vcc, 64, v231
    s_nop 1
    v_cndmask_b32 v239, v71, v238, vcc
    v_mov_b32 v156, -1
    v_mov_b32 v157, -1
    v_mov_b32 v158, -1
    v_mov_b32 v159, -1
    s_mul_i32 s38, s12, 10368
    s_lshl_b32 s32, s3, 10
    s_add_u32 s38, s38, s32
    s_add_u32 s38, s38, 1048576
    v_cvt_f32_u32 v220, v3
    v_mul_f32 v220, 0x3d000000, v220
    v_cvt_f32_u32 v221, v4
    v_mul_f32 v222, 4.0, v220
    v_mul_f32 v223, v221, v222
    s_mov_b32 s16, s4
    s_mov_b32 s17, s5
    s_mov_b32 s18, 25165824
    s_mov_b32 s19, 0x20000
    s_mov_b32 s20, s42
    s_mov_b32 s21, s43
    s_mov_b32 s22, 2621440
    s_movk_i32 s26, 256
    s_mov_b32 s46, 1314816
    s_mov_b32 s47, 0x20000
    s_mov_b32 s50, 1314816
    s_mov_b32 s51, 0x20000
    s_cmp_ge_u32 s3, 2
    s_cselect_b32 s28, s54, s52
    s_cselect_b32 s29, s55, s53
    s_mov_b32 s30, 1966080
    s_lshl_b32 s35, s3, 8
    s_add_u32 s35, s35, s12
    s_mul_i32 s36, s35, 1280
    s_add_u32 s37, s36, 1310720
    v_mul_u32_u24 v6, 20, v5
    v_lshlrev_b32 v7, 1, v6
    v_lshlrev_b32 v5, 3, v0
    s_lshr_b32 s34, s14, 5
    s_bfe_u32 s42, s14, 0x20003
    s_lshl_b32 s42, s42, 9
    s_add_u32 s42, s42, s34
    s_bfe_u32 s32, s14, 0x10002
    s_lshl_b32 s32, s32, 6
    s_add_u32 s42, s42, s32
    s_lshl_b32 s32, s3, 4
    s_add_u32 s42, s42, s32
    s_mul_i32 s42, s42, 642
    s_andn2_b32 s42, s42, 3
    s_and_b32 s32, s14, 3
    s_mul_i32 s43, s32, 160
    s_add_u32 s52, s42, s43
    s_and_b32 s53, s34, 1
    v_lshlrev_b32 v191, 3, v1
    v_add_u32 v66, 4968, v191
    v_cmp_gt_u32 vcc, 21, v1
    s_nop 1
    v_cndmask_b32 v191, v66, v191, vcc
    v_cmp_gt_u32 vcc, 42, v1
    s_nop 1
    v_cndmask_b32 v191, v71, v191, vcc
    v_cos_f32 v224, v223
    v_sin_f32 v225, v223
    v_add_f32 v223, v223, v220
    v_cvt_pk_bf16_f32 v8, v224, v225
    v_cvt_pk_bf16_f32 v24, -v225, v224
    v_cos_f32 v224, v223
    v_sin_f32 v225, v223
    v_add_f32 v223, v223, v220
    v_cvt_pk_bf16_f32 v9, v224, v225
    v_cvt_pk_bf16_f32 v25, -v225, v224
    v_cos_f32 v224, v223
    buffer_load_dwordx4 v[40:43], v6, s[20:23], s36 offen
    v_sin_f32 v225, v223
    v_add_f32 v223, v223, v220
    v_cvt_pk_bf16_f32 v10, v224, v225
    v_cvt_pk_bf16_f32 v26, -v225, v224
    v_cos_f32 v224, v223
    v_sin_f32 v225, v223
    v_add_f32 v223, v223, v220
    v_add_f32 v223, v223, v222
    v_cvt_pk_bf16_f32 v11, v224, v225
    v_cvt_pk_bf16_f32 v27, -v225, v224
    v_cos_f32 v224, v223
    v_sin_f32 v225, v223
    buffer_load_dword v44, v6, s[20:23], s36 offen offset:16
    v_add_f32 v223, v223, v220
    v_cvt_pk_bf16_f32 v12, v224, v225
    v_cvt_pk_bf16_f32 v28, -v225, v224
    v_cos_f32 v224, v223
    v_sin_f32 v225, v223
    v_add_f32 v223, v223, v220
    v_cvt_pk_bf16_f32 v13, v224, v225
    v_cvt_pk_bf16_f32 v29, -v225, v224
    v_cos_f32 v224, v223
    v_sin_f32 v225, v223
    v_add_f32 v223, v223, v220
    v_cvt_pk_bf16_f32 v14, v224, v225
    buffer_load_dwordx4 v[46:49], v6, s[20:23], s37 offen
    v_cvt_pk_bf16_f32 v30, -v225, v224
    v_cos_f32 v224, v223
    v_sin_f32 v225, v223
    v_add_f32 v223, v223, v220
    v_add_f32 v223, v223, v222
    v_cvt_pk_bf16_f32 v15, v224, v225
    v_cvt_pk_bf16_f32 v31, -v225, v224
    v_and_b32 v224, 1, v3
    v_mul_u32_u24 v224, 0x8000, v224
    v_lshl_or_b32 v224, v224, 16, v224
    v_xor_b32 v16, v224, v8
    v_xor_b32 v32, v224, v24
    v_xor_b32 v17, v224, v9
    v_xor_b32 v33, v224, v25
    buffer_load_dword v50, v6, s[20:23], s37 offen offset:16
    v_xor_b32 v18, v224, v10
    v_xor_b32 v34, v224, v26
    v_xor_b32 v19, v224, v11
    v_xor_b32 v35, v224, v27
    v_xor_b32 v20, v224, v12
    v_xor_b32 v36, v224, v28
    v_xor_b32 v21, v224, v13
    v_xor_b32 v37, v224, v29
    v_xor_b32 v22, v224, v14
    v_xor_b32 v38, v224, v30
    v_xor_b32 v23, v224, v15
    v_xor_b32 v39, v224, v31
    v_mul_f32 v220, 0x3d4ccccd, v220
    v_mul_f32 v221, 0x41200000, v221
    v_mul_f32 v223, v221, v220
    v_cos_f32 v96, v223
    v_sin_f32 v106, v223
    v_add_f32 v223, v223, v220
    v_cos_f32 v97, v223
    v_sin_f32 v107, v223
    v_add_f32 v223, v223, v220
    v_cos_f32 v98, v223
    v_sin_f32 v108, v223
    v_add_f32 v223, v223, v220
    v_cos_f32 v99, v223
    v_sin_f32 v109, v223
    v_add_f32 v223, v223, v220
    v_cos_f32 v100, v223
    v_sin_f32 v110, v223
    v_add_f32 v223, v223, v220
    v_cos_f32 v101, v223
    v_sin_f32 v111, v223
    v_add_f32 v223, v223, v220
    v_cos_f32 v102, v223
    v_sin_f32 v112, v223
    v_add_f32 v223, v223, v220
    v_cos_f32 v103, v223
    v_sin_f32 v113, v223
    v_add_f32 v223, v223, v220
    v_cos_f32 v104, v223
    v_sin_f32 v114, v223
    v_add_f32 v223, v223, v220
    v_cos_f32 v105, v223
    v_sin_f32 v115, v223
    v_lshrrev_b32 v56, 4, v0
    v_lshlrev_b32 v56, 8, v56
    v_lshl_add_u32 v67, v190, 5, v56
    s_waitcnt vmcnt(9)
    v_lshlrev_b32 v244, 16, v244
    v_lshlrev_b32 v245, 16, v245
    v_lshlrev_b32 v246, 16, v246
    v_lshlrev_b32 v247, 16, v247
    v_lshlrev_b32 v248, 16, v248
    v_mul_f32 v57, 0xbfb8aa3b, v244
    v_mul_f32 v58, 0xbfb8aa3b, v245
    v_mul_f32 v59, 0xbfb8aa3b, v246
    v_mul_f32 v60, 0xbfb8aa3b, v247
    v_mul_f32 v61, 0xbfb8aa3b, v248
    v_exp_f32 v57, v57
    v_exp_f32 v58, v58
    v_exp_f32 v59, v59
    v_exp_f32 v60, v60
    v_exp_f32 v61, v61
    v_add_f32 v57, 1.0, v57
    v_add_f32 v58, 1.0, v58
    v_add_f32 v59, 1.0, v59
    v_add_f32 v60, 1.0, v60
    v_add_f32 v61, 1.0, v61
    v_rcp_f32 v57, v57
    v_rcp_f32 v58, v58
    v_rcp_f32 v59, v59
    v_rcp_f32 v60, v60
    v_rcp_f32 v61, v61
    v_mul_f32 v244, v244, v57
    v_mul_f32 v245, v245, v58
    v_mul_f32 v246, v246, v59
    v_mul_f32 v247, v247, v60
    v_mul_f32 v248, v248, v61
    v_cvt_pk_bf16_f32 v244, v244, v244
    v_cvt_pk_bf16_f32 v245, v245, v245
    v_cvt_pk_bf16_f32 v246, v246, v246
    v_cvt_pk_bf16_f32 v247, v247, v247
    v_cvt_pk_bf16_f32 v248, v248, v248
    v_and_b32 v244, s13, v244
    v_and_b32 v245, s13, v245
    v_and_b32 v246, s13, v246
    v_and_b32 v247, s13, v247
    v_and_b32 v248, s13, v248
    s_waitcnt vmcnt(8)
    v_lshlrev_b32 v52, 16, v160
    v_and_b32 v53, s13, v160
    v_pk_mul_f32 v[180:181], v[52:53], v[244:245] op_sel:[0,0] op_sel_hi:[1,0]
    v_lshlrev_b32 v54, 16, v161
    v_and_b32 v55, s13, v161
    v_pk_mul_f32 v[182:183], v[54:55], v[244:245] op_sel:[0,0] op_sel_hi:[1,0]
    v_lshlrev_b32 v52, 16, v162
    v_and_b32 v53, s13, v162
    v_pk_mul_f32 v[184:185], v[52:53], v[244:245] op_sel:[0,0] op_sel_hi:[1,0]
    v_lshlrev_b32 v54, 16, v163
    v_and_b32 v55, s13, v163
    v_pk_mul_f32 v[186:187], v[54:55], v[244:245] op_sel:[0,0] op_sel_hi:[1,0]
    s_waitcnt vmcnt(7)
    v_lshlrev_b32 v52, 16, v164
    v_and_b32 v53, s13, v164
    v_pk_fma_f32 v[180:181], v[52:53], v[244:245], v[180:181] op_sel:[0,1,0] op_sel_hi:[1,1,1]
    v_lshlrev_b32 v54, 16, v165
    v_and_b32 v55, s13, v165
    v_pk_fma_f32 v[182:183], v[54:55], v[244:245], v[182:183] op_sel:[0,1,0] op_sel_hi:[1,1,1]
    v_lshlrev_b32 v52, 16, v166
    v_and_b32 v53, s13, v166
    v_pk_fma_f32 v[184:185], v[52:53], v[244:245], v[184:185] op_sel:[0,1,0] op_sel_hi:[1,1,1]
    v_lshlrev_b32 v54, 16, v167
    v_and_b32 v55, s13, v167
    v_pk_fma_f32 v[186:187], v[54:55], v[244:245], v[186:187] op_sel:[0,1,0] op_sel_hi:[1,1,1]
    s_waitcnt vmcnt(6)
    buffer_load_dwordx2 v[64:65], v188, s[24:27], 0 offen sc1
    v_lshlrev_b32 v52, 16, v168
    v_and_b32 v53, s13, v168
    v_pk_fma_f32 v[180:181], v[52:53], v[246:247], v[180:181] op_sel:[0,0,0] op_sel_hi:[1,0,1]
    v_lshlrev_b32 v54, 16, v169
    v_and_b32 v55, s13, v169
    v_pk_fma_f32 v[182:183], v[54:55], v[246:247], v[182:183] op_sel:[0,0,0] op_sel_hi:[1,0,1]
    v_lshlrev_b32 v52, 16, v170
    v_and_b32 v53, s13, v170
    v_pk_fma_f32 v[184:185], v[52:53], v[246:247], v[184:185] op_sel:[0,0,0] op_sel_hi:[1,0,1]
    v_lshlrev_b32 v54, 16, v171
    v_and_b32 v55, s13, v171
    v_pk_fma_f32 v[186:187], v[54:55], v[246:247], v[186:187] op_sel:[0,0,0] op_sel_hi:[1,0,1]
    s_waitcnt vmcnt(6)
    v_lshlrev_b32 v52, 16, v172
    v_and_b32 v53, s13, v172
    v_pk_fma_f32 v[180:181], v[52:53], v[246:247], v[180:181] op_sel:[0,1,0] op_sel_hi:[1,1,1]
    v_lshlrev_b32 v54, 16, v173
    v_and_b32 v55, s13, v173
    v_pk_fma_f32 v[182:183], v[54:55], v[246:247], v[182:183] op_sel:[0,1,0] op_sel_hi:[1,1,1]
    v_lshlrev_b32 v52, 16, v174
    v_and_b32 v53, s13, v174
    v_pk_fma_f32 v[184:185], v[52:53], v[246:247], v[184:185] op_sel:[0,1,0] op_sel_hi:[1,1,1]
    v_lshlrev_b32 v54, 16, v175
    v_and_b32 v55, s13, v175
    v_pk_fma_f32 v[186:187], v[54:55], v[246:247], v[186:187] op_sel:[0,1,0] op_sel_hi:[1,1,1]
    s_waitcnt vmcnt(5)
    v_lshlrev_b32 v52, 16, v176
    v_and_b32 v53, s13, v176
    v_pk_fma_f32 v[180:181], v[52:53], v[248:249], v[180:181] op_sel:[0,0,0] op_sel_hi:[1,0,1]
    v_lshlrev_b32 v54, 16, v177
    v_and_b32 v55, s13, v177
    v_pk_fma_f32 v[182:183], v[54:55], v[248:249], v[182:183] op_sel:[0,0,0] op_sel_hi:[1,0,1]
    v_lshlrev_b32 v52, 16, v178
    v_and_b32 v53, s13, v178
    v_pk_fma_f32 v[184:185], v[52:53], v[248:249], v[184:185] op_sel:[0,0,0] op_sel_hi:[1,0,1]
    v_lshlrev_b32 v54, 16, v179
    v_and_b32 v55, s13, v179
    v_pk_fma_f32 v[186:187], v[54:55], v[248:249], v[186:187] op_sel:[0,0,0] op_sel_hi:[1,0,1]
    v_add_f32_dpp v180, v180, v180 row_ror:8 row_mask:0xf bank_mask:0xf
    v_add_f32_dpp v181, v181, v181 row_ror:8 row_mask:0xf bank_mask:0xf
    v_add_f32_dpp v182, v182, v182 row_ror:8 row_mask:0xf bank_mask:0xf
    v_add_f32_dpp v183, v183, v183 row_ror:8 row_mask:0xf bank_mask:0xf
    v_add_f32_dpp v184, v184, v184 row_ror:8 row_mask:0xf bank_mask:0xf
    v_add_f32_dpp v185, v185, v185 row_ror:8 row_mask:0xf bank_mask:0xf
    v_add_f32_dpp v186, v186, v186 row_ror:8 row_mask:0xf bank_mask:0xf
    v_add_f32_dpp v187, v187, v187 row_ror:8 row_mask:0xf bank_mask:0xf
    s_mov_b32 s42, 0xff00ff
    s_mov_b32 s43, 0xff00ff
    s_mov_b64 exec, s[42:43]
    ds_write_b128 v67, v[180:183]
    ds_write_b128 v67, v[184:187] offset:16
    s_mov_b64 exec, -1
    v_mul_u32_u24 v232, 1440, v4
    v_lshl_add_u32 v232, v3, 2, v232
    s_mul_i32 s35, s3, 2880
    s_add_u32 s35, s35, 140800
    v_add_u32 v232, s35, v232
    v_and_b32 v226, 3, v3
    v_lshrrev_b32 v227, 3, v3
    v_lshl_add_u32 v226, v227, 2, v226
    v_min_u32 v226, 9, v226
    v_bfe_u32 v227, v3, 2, 1
    buffer_load_dwordx2 v[140:141], v191, s[44:47], s52 offen
    v_mad_u32_u24 v226, v227, 10, v226
    v_mul_u32_u24 v233, 144, v226
    v_lshl_add_u32 v233, v4, 4, v233
    v_add_u32 v233, s35, v233
    v_cvt_f32_u32 v220, v226
    v_mul_f32 v220, 0x3d4ccccd, v220
    v_mul_f32 v223, v221, v220
    v_cos_f32 v224, v223
    v_sin_f32 v225, v223
    buffer_load_dwordx2 v[142:143], v191, s[48:51], s52 offen
    v_add_f32 v223, v223, v220
    v_cvt_pk_bf16_f32 v72, v224, v225
    v_cvt_pk_bf16_f32 v84, -v225, v224
    v_cos_f32 v224, v223
    v_sin_f32 v225, v223
    v_add_f32 v223, v223, v220
    v_cvt_pk_bf16_f32 v73, v224, v225
    v_cvt_pk_bf16_f32 v85, -v225, v224
    s_add_u32 s52, s52, 82176
    buffer_load_dwordx2 v[144:145], v191, s[44:47], s52 offen
    v_cos_f32 v224, v223
    v_sin_f32 v225, v223
    v_add_f32 v223, v223, v220
    v_cvt_pk_bf16_f32 v74, v224, v225
    v_cvt_pk_bf16_f32 v86, -v225, v224
    v_cos_f32 v224, v223
    v_sin_f32 v225, v223
    buffer_load_dwordx2 v[146:147], v191, s[48:51], s52 offen
    v_add_f32 v223, v223, v220
    v_cvt_pk_bf16_f32 v75, v224, v225
    v_cvt_pk_bf16_f32 v87, -v225, v224
    v_cos_f32 v224, v223
    v_sin_f32 v225, v223
    v_add_f32 v223, v223, v220
    v_cvt_pk_bf16_f32 v76, v224, v225
    v_cvt_pk_bf16_f32 v88, -v225, v224
    s_add_u32 s52, s52, 82176
    buffer_load_dwordx2 v[148:149], v191, s[44:47], s52 offen
    v_cos_f32 v224, v223
    v_sin_f32 v225, v223
    v_add_f32 v223, v223, v220
    v_cvt_pk_bf16_f32 v77, v224, v225
    v_cvt_pk_bf16_f32 v89, -v225, v224
    v_cos_f32 v224, v223
    v_sin_f32 v225, v223
    buffer_load_dwordx2 v[150:151], v191, s[48:51], s52 offen
    v_add_f32 v223, v223, v220
    v_cvt_pk_bf16_f32 v78, v224, v225
    v_cvt_pk_bf16_f32 v90, -v225, v224
    v_cos_f32 v224, v223
    v_sin_f32 v225, v223
    v_add_f32 v223, v223, v220
    v_cvt_pk_bf16_f32 v79, v224, v225
    v_cvt_pk_bf16_f32 v91, -v225, v224
    s_add_u32 s52, s52, 82176
    buffer_load_dwordx2 v[152:153], v191, s[44:47], s52 offen
    v_cos_f32 v224, v223
    v_sin_f32 v225, v223
    v_add_f32 v223, v223, v220
    v_cvt_pk_bf16_f32 v80, v224, v225
    v_cvt_pk_bf16_f32 v92, -v225, v224
    v_cos_f32 v224, v223
    v_sin_f32 v225, v223
    buffer_load_dwordx2 v[154:155], v191, s[48:51], s52 offen
    v_add_f32 v223, v223, v220
    v_cvt_pk_bf16_f32 v81, v224, v225
    v_cvt_pk_bf16_f32 v93, -v225, v224
    v_mov_b32 v82, 0
    v_mov_b32 v83, 0
    v_mov_b32 v94, 0
    v_mov_b32 v95, 0
    s_waitcnt vmcnt(8)
    v_readfirstlane_b32 s8, v64
    v_readfirstlane_b32 s9, v65
    s_mov_b32 s32, 16384
LnpA:
    s_cmp_lg_u32 s9, 0
    s_cbranch_scc1 LnpA_x
    buffer_load_dwordx2 v[64:65], v188, s[24:27], 0 offen sc1
    s_waitcnt vmcnt(0)
    v_readfirstlane_b32 s8, v64
    v_readfirstlane_b32 s9, v65
    s_sub_u32 s32, s32, 1
    s_cbranch_scc0 LnpA
LnpA_x:
    v_lshlrev_b32 v53, 2, v1
    s_waitcnt lgkmcnt(0)
    s_barrier
    ds_read_b32 v160, v53 offset:0
    ds_read_b32 v161, v53 offset:256
    ds_read_b32 v162, v53 offset:512
    ds_read_b32 v163, v53 offset:768
    ds_read_b32 v164, v53 offset:1024
    ds_read_b32 v165, v53 offset:1280
    ds_read_b32 v166, v53 offset:1536
    ds_read_b32 v167, v53 offset:1792
    ds_read_b32 v168, v53 offset:2048
    ds_read_b32 v169, v53 offset:2304
    ds_read_b32 v170, v53 offset:2560
    ds_read_b32 v171, v53 offset:2816
    ds_read_b32 v172, v53 offset:3072
    ds_read_b32 v173, v53 offset:3328
    ds_read_b32 v174, v53 offset:3584
    ds_read_b32 v175, v53 offset:3840
    s_and_b32 s34, s60, 3
    s_mul_i32 s34, s34, 10240
    s_lshr_b32 s32, s60, 2
    s_lshl_b32 s35, s32, 9
    s_add_u32 s35, s35, s34
    s_add_u32 s35, s35, 131072
    s_lshl_b32 s39, s32, 8
    s_add_u32 s39, s39, s34
    s_add_u32 s39, s39, 191488
    s_cmp_lt_u32 s60, 80
    s_cselect_b32 s42, 0, 1073741824
    s_cselect_b32 s43, 1073741824, 0
    s_cmp_lt_u32 s60, 240
    s_cselect_b32 s43, s43, 1073741824
    s_cmp_eq_u32 s3, 0
    s_cselect_b32 s42, s42, 1073741824
    s_cselect_b32 s43, s43, 1073741824
    v_lshl_add_u32 v52, v1, 3, s42
    v_add_u32 v53, s43, v53
    v_mov_b32 v177, s8
    v_mov_b32 v179, s9
    s_mov_b32 s42, 0x55555555
    s_mov_b32 s43, 0x55555555
    s_waitcnt lgkmcnt(0)
    v_pk_add_f32 v[160:161], v[160:161], v[168:169]
    v_pk_add_f32 v[162:163], v[162:163], v[170:171]
    v_pk_add_f32 v[164:165], v[164:165], v[172:173]
    v_pk_add_f32 v[166:167], v[166:167], v[174:175]
    v_pk_add_f32 v[160:161], v[160:161], v[164:165]
    v_pk_add_f32 v[162:163], v[162:163], v[166:167]
    v_pk_add_f32 v[160:161], v[160:161], v[162:163]
    v_add_f32 v176, v160, v161
    s_nop 1
    v_mov_b32_dpp v178, v176 quad_perm:[1,1,3,3] row_mask:0xf bank_mask:0xf
    s_mov_b64 exec, s[42:43]
    buffer_store_dwordx4 v[176:179], v52, s[16:19], s35 offen sc1
    s_mov_b64 exec, -1
    buffer_store_dword v176, v53, s[16:19], s39 offen sc1
    s_add_u32 s54, s38, 0
    buffer_store_dwordx4 v[156:159], v238, s[16:19], s54 offen sc1
    s_add_u32 s54, s38, 4096
    buffer_store_dwordx4 v[156:159], v238, s[16:19], s54 offen sc1
    v_mul_u32_u24 v249, 10923, v1
    v_lshrrev_b32 v249, 16, v249
    v_mul_u32_u24 v249, 2304, v249
    v_lshl_add_u32 v249, v1, 7, v249
    s_and_b32 s32, s3, 1
    s_lshl_b32 s32, s32, 30
    v_add_u32 v249, s32, v249
    s_mul_i32 s35, s61, 30720
    s_andn2_b32 s32, s11, 3
    s_mul_i32 s32, s32, 192
    s_add_u32 s35, s35, s32
    v_add_u32 v249, s35, v249
    s_waitcnt vmcnt(13)
    v_dot2_f32_bf16 v208, v40, s33, 0
    v_dot2_f32_bf16 v209, v46, s33, 0
    s_add_u32 s54, s38, 8192
    buffer_store_dwordx4 v[156:159], v239, s[16:19], s54 offen sc1
    v_dot2_f32_bf16 v210, v40, v40, 0
    v_dot2_f32_bf16 v211, v46, v46, 0
    v_dot2_f32_bf16 v208, v41, s33, v208
    v_dot2_f32_bf16 v209, v47, s33, v209
    v_dot2_f32_bf16 v210, v41, v41, v210
    v_dot2_f32_bf16 v211, v47, v47, v211
    v_dot2_f32_bf16 v208, v42, s33, v208
    v_dot2_f32_bf16 v209, v48, s33, v209
    v_dot2_f32_bf16 v210, v42, v42, v210
    v_dot2_f32_bf16 v211, v48, v48, v211
    v_dot2_f32_bf16 v208, v43, s33, v208
    v_dot2_f32_bf16 v209, v49, s33, v209
    v_dot2_f32_bf16 v210, v43, v43, v210
    v_dot2_f32_bf16 v211, v49, v49, v211
    buffer_load_dword v255, v249, s[28:31], 0 offen
    v_dot2_f32_bf16 v208, v44, s33, v208
    v_dot2_f32_bf16 v209, v50, s33, v209
    v_dot2_f32_bf16 v210, v44, v44, v210
    v_dot2_f32_bf16 v211, v50, v50, v211
    v_add_f32_dpp v208, v208, v208 quad_perm:[1,0,3,2] row_mask:0xf bank_mask:0xf
    v_add_f32_dpp v209, v209, v209 quad_perm:[1,0,3,2] row_mask:0xf bank_mask:0xf
    v_add_f32_dpp v210, v210, v210 quad_perm:[1,0,3,2] row_mask:0xf bank_mask:0xf
    v_add_f32_dpp v211, v211, v211 quad_perm:[1,0,3,2] row_mask:0xf bank_mask:0xf
    v_add_f32_dpp v208, v208, v208 quad_perm:[2,3,0,1] row_mask:0xf bank_mask:0xf
    v_add_f32_dpp v209, v209, v209 quad_perm:[2,3,0,1] row_mask:0xf bank_mask:0xf
    v_add_f32_dpp v210, v210, v210 quad_perm:[2,3,0,1] row_mask:0xf bank_mask:0xf
    v_add_f32_dpp v211, v211, v211 quad_perm:[2,3,0,1] row_mask:0xf bank_mask:0xf
    v_add_f32_dpp v208, v208, v208 row_ror:4 row_mask:0xf bank_mask:0xf
    v_add_f32_dpp v209, v209, v209 row_ror:4 row_mask:0xf bank_mask:0xf
    v_add_f32_dpp v210, v210, v210 row_ror:4 row_mask:0xf bank_mask:0xf
    v_add_f32_dpp v211, v211, v211 row_ror:4 row_mask:0xf bank_mask:0xf
    v_add_f32_dpp v208, v208, v208 row_ror:8 row_mask:0xf bank_mask:0xf
    v_add_f32_dpp v209, v209, v209 row_ror:8 row_mask:0xf bank_mask:0xf
    v_add_f32_dpp v210, v210, v210 row_ror:8 row_mask:0xf bank_mask:0xf
    v_add_f32_dpp v211, v211, v211 row_ror:8 row_mask:0xf bank_mask:0xf
    v_add_f32_dpp v208, v208, v208 row_bcast:15 row_mask:0xa bank_mask:0xf
    v_add_f32_dpp v209, v209, v209 row_bcast:15 row_mask:0xa bank_mask:0xf
    v_add_f32_dpp v210, v210, v210 row_bcast:15 row_mask:0xa bank_mask:0xf
    v_add_f32_dpp v211, v211, v211 row_bcast:15 row_mask:0xa bank_mask:0xf
    v_add_f32_dpp v208, v208, v208 row_bcast:31 row_mask:0xc bank_mask:0xf
    v_add_f32_dpp v209, v209, v209 row_bcast:31 row_mask:0xc bank_mask:0xf
    v_add_f32_dpp v210, v210, v210 row_bcast:31 row_mask:0xc bank_mask:0xf
    v_add_f32_dpp v211, v211, v211 row_bcast:31 row_mask:0xc bank_mask:0xf
    v_readlane_b32 s56, v208, 63
    v_readlane_b32 s57, v209, 63
    v_readlane_b32 s58, v210, 63
    v_readlane_b32 s59, v211, 63
    v_mov_b32 v212, 0x3acccccd
    v_mov_b32 v213, 0x3727c5ac
    v_pk_mul_f32 v[214:215], v[212:213], s[56:57] op_sel_hi:[0,1]
    v_pk_fma_f32 v[208:209], v[212:213], s[58:59], v[212:213] op_sel:[0,0,1] op_sel_hi:[0,1,1]
    v_pk_fma_f32 v[208:209], v[214:215], v[214:215], v[208:209] neg_lo:[1,0,0] neg_hi:[1,0,0]
    v_max_f32 v208, v213, v208
    v_max_f32 v209, v213, v209
    v_rsq_f32 v208, v208
    v_rsq_f32 v209, v209
    v_lshlrev_b32 v120, 16, v40
    v_and_b32 v122, s13, v40
    v_lshlrev_b32 v121, 16, v46
    v_and_b32 v123, s13, v46
    v_lshlrev_b32 v124, 16, v41
    v_and_b32 v126, s13, v41
    v_lshlrev_b32 v125, 16, v47
    v_and_b32 v127, s13, v47
    v_lshlrev_b32 v128, 16, v42
    v_and_b32 v130, s13, v42
    v_lshlrev_b32 v129, 16, v48
    v_and_b32 v131, s13, v48
    v_lshlrev_b32 v132, 16, v43
    v_and_b32 v134, s13, v43
    v_lshlrev_b32 v133, 16, v49
    v_and_b32 v135, s13, v49
    v_lshlrev_b32 v136, 16, v44
    v_and_b32 v138, s13, v44
    v_lshlrev_b32 v137, 16, v50
    v_and_b32 v139, s13, v50
    v_pk_mul_f32 v[210:211], v[214:215], v[208:209] neg_lo:[1,0] neg_hi:[1,0]
    v_pk_fma_f32 v[120:121], v[120:121], v[208:209], v[210:211]
    v_pk_fma_f32 v[122:123], v[122:123], v[208:209], v[210:211]
    v_pk_fma_f32 v[124:125], v[124:125], v[208:209], v[210:211]
    v_pk_fma_f32 v[126:127], v[126:127], v[208:209], v[210:211]
    v_pk_fma_f32 v[128:129], v[128:129], v[208:209], v[210:211]
    v_pk_fma_f32 v[130:131], v[130:131], v[208:209], v[210:211]
    v_pk_fma_f32 v[132:133], v[132:133], v[208:209], v[210:211]
    v_pk_fma_f32 v[134:135], v[134:135], v[208:209], v[210:211]
    v_pk_fma_f32 v[136:137], v[136:137], v[208:209], v[210:211]
    v_pk_fma_f32 v[138:139], v[138:139], v[208:209], v[210:211]
    v_mul_u32_u24 v56, 576, v1
    v_add_u32 v57, -12080, v56
    v_cmp_gt_u32 vcc, 21, v1
    s_nop 1
    v_cndmask_b32 v56, v57, v56, vcc
    s_lshl_b32 s32, s3, 5
    s_add_u32 s32, s32, 130560
    v_add_u32 v56, s32, v56
    v_lshrrev_b32 v191, 3, v0
    v_add_u32 v57, s53, v191
    v_mul_u32_u24 v57, 144, v57
    v_lshl_add_u32 v57, v190, 4, v57
    v_add_u32 v57, 130560, v57
    v_lshlrev_b32 v61, 13, v191
    v_lshl_add_u32 v61, v190, 4, v61
    s_and_b32 s32, s14, 3
    s_cmp_eq_u32 s32, 3
    s_cselect_b32 s35, 17, 16
    v_cmp_gt_u32 vcc, s35, v191
    s_nop 1
    v_cndmask_b32 v62, v71, v61, vcc
    s_mul_i32 s52, s32, 655360
    s_lshr_b32 s35, s14, 2
    s_lshl_b32 s35, s35, 7
    s_add_u32 s52, s52, s35
    s_add_u32 s52, s52, 7340032
    s_add_u32 s53, s52, 262144
    s_add_u32 s54, s52, 524288
    v_lshlrev_b32 v63, 4, v0
    v_add_u32 v59, 4096, v63
    v_lshrrev_b32 v58, 1, v63
    v_add_u32 v60, 8192, v58
    s_mov_b32 s56, 131072
    s_mov_b32 s57, 141312
    s_mov_b32 s58, 151552
    s_mov_b32 s59, 161792
    v_mov_b32 v68, s8
    v_mov_b32 v69, s9
    v_and_b32 v70, 1, v0
    v_cmp_eq_u32 vcc, 0, v70
    s_nop 1
    v_cndmask_b32 v68, v69, v68, vcc
    v_lshrrev_b32 v69, 1, v58
    v_add_u32 v58, 125440, v58
    v_add_u32 v69, 129536, v69
    v_add_u32 v243, 125440, v7
    s_cmp_eq_u32 s3, 0
    s_cselect_b32 s49, 0, 1.0
    s_mov_b32 s24, s40
    s_mov_b32 s25, s41
    s_mov_b32 s26, 2621440
    v_mov_b32 v240, s8
    v_mov_b32 v241, s9
    s_lshl_b32 s35, s2, 3
    s_cmp_eq_u32 s3, 0
    s_cselect_b32 s35, s35, 1073741824
    v_mov_b32 v242, s35
    v_mul_u32_u24 v234, 5120, v4
    v_lshl_add_u32 v234, v3, 4, v234
    s_lshl_b32 s35, s3, 2
    s_add_u32 s35, s35, 130560
    v_add_u32 v234, s35, v234
    v_mov_b32 v228, 0x3e800000
    v_and_b32 v220, 4, v3
    v_bfe_u32 v221, v3, 3, 1
    v_lshl_add_u32 v220, v221, 1, v220
    v_bfe_u32 v221, v3, 1, 1
    v_add_u32 v220, v220, v221
    v_cvt_f32_u32 v220, v220
    v_xor_b32 v221, v221, v4
    v_and_b32 v222, 1, v3
    v_sub_u32 v221, v222, v221
    v_cvt_f32_i32 v221, v221
    v_fmaak_f32 v221, v228, v221, 0x3e000000
    v_cvt_f32_u32 v222, s12
    v_mul_f32 v222, 0x3a000000, v222
    v_fma_f32 v223, v220, v222, v221
    v_mul_f32 v220, 0x3e000000, v220
    v_cvt_f32_u32 v222, v4
    v_fmaak_f32 v222, 0.5, v222, 0xbe800000
    v_add_f32 v225, v223, v222
    v_cos_f32 v224, v223
    v_cos_f32 v225, v225
    v_add_f32 v223, v223, v220
    v_cvt_pk_bf16_f32 v116, v224, v225
    v_add_f32 v225, v223, v222
    v_cos_f32 v224, v223
    v_cos_f32 v225, v225
    v_add_f32 v223, v223, v220
    v_cvt_pk_bf16_f32 v117, v224, v225
    v_add_f32 v225, v223, v222
    v_cos_f32 v224, v223
    v_cos_f32 v225, v225
    v_add_f32 v223, v223, v220
    v_cvt_pk_bf16_f32 v118, v224, v225
    v_add_f32 v225, v223, v222
    v_cos_f32 v224, v223
    v_cos_f32 v225, v225
    v_add_f32 v223, v223, v220
    v_cvt_pk_bf16_f32 v119, v224, v225
    v_cmp_eq_u32 vcc, 0, v4
    v_sub_u32 v221, 640, v231
    s_nop 0
    v_cndmask_b32 v222, v221, v231, vcc
    v_mov_b32 v223, 0xfffff800
    v_mov_b32 v224, 0x800
    v_cndmask_b32 v223, v223, v224, vcc
    v_lshlrev_b32 v222, 4, v222
    v_add_u32 v222, 130560, v222
    v_add_u32 v236, v222, v223
    v_add_u32 v237, v236, v223
    v_mov_b32 v224, 130560
    v_cmp_eq_u32 vcc, 0, v231
    s_nop 1
    v_cndmask_b32 v235, v222, v224, vcc
    v_mov_b32 v218, 0
    v_mov_b32 v219, 0
    buffer_load_dwordx4 v[160:163], v63, s[16:19], s56 offen sc1
    buffer_load_dwordx4 v[176:179], v59, s[16:19], s56 offen sc1
    buffer_load_dwordx2 v[192:193], v60, s[16:19], s56 offen sc1
    buffer_load_dwordx4 v[164:167], v63, s[16:19], s57 offen sc1
    buffer_load_dwordx4 v[180:183], v59, s[16:19], s57 offen sc1
    buffer_load_dwordx2 v[194:195], v60, s[16:19], s57 offen sc1
    buffer_load_dwordx4 v[168:171], v63, s[16:19], s58 offen sc1
    buffer_load_dwordx4 v[184:187], v59, s[16:19], s58 offen sc1
    buffer_load_dwordx2 v[196:197], v60, s[16:19], s58 offen sc1
    buffer_load_dwordx4 v[172:175], v63, s[16:19], s59 offen sc1
    buffer_load_dwordx4 v[188:191], v59, s[16:19], s59 offen sc1
    buffer_load_dwordx2 v[198:199], v60, s[16:19], s59 offen sc1
    s_mov_b32 s34, 0x05040100
    s_mov_b32 s35, 0x07060302
    s_waitcnt vmcnt(18)
    v_cmp_gt_u32 vcc, 42, v1
    s_nop 0
    s_and_saveexec_b64 s[42:43], vcc
    v_perm_b32 v200, v142, v140, s34
    v_perm_b32 v201, v146, v144, s34
    v_perm_b32 v202, v150, v148, s34
    v_perm_b32 v203, v154, v152, s34
    ds_write_b128 v56, v[200:203] offset:0
    v_perm_b32 v204, v142, v140, s35
    v_perm_b32 v205, v146, v144, s35
    v_perm_b32 v206, v150, v148, s35
    v_perm_b32 v207, v154, v152, s35
    ds_write_b128 v56, v[204:207] offset:144
    v_perm_b32 v208, v143, v141, s34
    v_perm_b32 v209, v147, v145, s34
    v_perm_b32 v210, v151, v149, s34
    v_perm_b32 v211, v155, v153, s34
    ds_write_b128 v56, v[208:211] offset:288
    v_perm_b32 v212, v143, v141, s35
    v_perm_b32 v213, v147, v145, s35
    v_perm_b32 v214, v151, v149, s35
    v_perm_b32 v215, v155, v153, s35
    ds_write_b128 v56, v[212:215] offset:432
    s_mov_b64 exec, s[42:43]
    s_mul_i32 s62, s15, 12288
    s_mul_i32 s35, s3, 3072
    s_add_u32 s62, s62, s35
    s_add_u32 s62, s62, 4194304
    v_add_u32 v220, s63, v2
    s_lshl_b32 s40, s12, 3
    s_add_u32 s40, s40, s3
    s_mul_i32 s40, s40, 1280
    s_add_u32 s40, s40, 10485760
    v_mul_u32_u24 v221, 5120, v4
    v_lshl_add_u32 v221, v3, 4, v221
    v_cmp_gt_u32 vcc, 24, v3
    s_nop 1
    v_cndmask_b32 v221, v71, v221, vcc
    v_mul_u32_u24 v222, 5462, v1
    v_lshrrev_b32 v222, 16, v222
    v_mul_u32_u24 v252, 2880, v222
    v_add_u32 v252, v252, v2
    v_add_u32 v222, 64, v1
    v_mul_u32_u24 v222, 5462, v222
    v_lshrrev_b32 v222, 16, v222
    v_mul_u32_u24 v253, 2880, v222
    v_add_u32 v253, v253, v2
    v_add_u32 v222, -32, v253
    v_cmp_lt_u32 vcc, 57, v1
    s_nop 1
    v_cndmask_b32 v253, v253, v222, vcc
    s_and_b32 s32, s3, 1
    s_mul_i32 s39, s32, 245760
    s_mul_i32 s42, s11, 192
    s_add_u32 s39, s39, s42
    s_mul_i32 s55, s32, 15616
    s_lshr_b32 s32, s3, 1
    s_mul_i32 s32, s32, 31344
    s_add_u32 s55, s55, s32
    s_waitcnt vmcnt(13) lgkmcnt(0)
    s_barrier
    ds_read_b128 v[140:143], v57 offset:0
    ds_read_b128 v[144:147], v57 offset:4608
    ds_read_b128 v[148:151], v57 offset:9216
    s_mov_b32 s35, 262144
    s_mov_b64 exec, 1
    buffer_atomic_swap_x2 v[240:241], v242, s[16:19], s35 offen sc1
    s_mov_b64 exec, -1
    s_and_b32 s32, s2, 7
    s_mul_i32 s32, s32, 24
    s_add_u32 s32, s32, s61
    s_lshl_b32 s32, s32, 1
    s_add_u32 s14, s32, s3
    s_mov_b32 s44, s6
    s_mov_b32 s45, s7
    s_cmp_lt_u32 s61, 24
    s_cselect_b32 s46, 1966080, 0
    s_cmp_lt_u32 s3, 2
    s_cselect_b32 s46, s46, 0
    s_mov_b32 s47, 0x20000
    s_lshr_b32 s51, s14, 3
    s_mul_i32 s51, s51, 40960
    s_and_b32 s32, s14, 7
    s_mul_i32 s32, s32, 160
    s_add_u32 s51, s51, s32
    s_mul_i32 s6, s3, 5120
    s_add_u32 s6, s6, 153600
    v_add_u32 v227, 0, v1
    v_mul_u32_u24 v228, 6554, v227
    v_lshrrev_b32 v228, 16, v228
    v_mul_u32_u24 v228, 1120, v228
    v_lshl_add_u32 v222, v227, 4, v228
    v_add_u32 v227, 64, v1
    v_mul_u32_u24 v228, 6554, v227
    v_lshrrev_b32 v228, 16, v228
    v_mul_u32_u24 v228, 1120, v228
    v_lshl_add_u32 v223, v227, 4, v228
    v_add_u32 v227, 128, v1
    v_mul_u32_u24 v228, 6554, v227
    v_lshrrev_b32 v228, 16, v228
    v_mul_u32_u24 v228, 1120, v228
    v_lshl_add_u32 v224, v227, 4, v228
    v_add_u32 v227, 192, v1
    v_mul_u32_u24 v228, 6554, v227
    v_lshrrev_b32 v228, 16, v228
    v_mul_u32_u24 v228, 1120, v228
    v_lshl_add_u32 v225, v227, 4, v228
    v_add_u32 v227, 256, v1
    v_mul_u32_u24 v228, 6554, v227
    v_lshrrev_b32 v228, 16, v228
    v_mul_u32_u24 v228, 1120, v228
    v_lshl_add_u32 v226, v227, 4, v228
    s_waitcnt lgkmcnt(0)
    buffer_store_dwordx4 v[140:143], v61, s[16:19], s52 offen sc1
    buffer_store_dwordx4 v[144:147], v61, s[16:19], s53 offen sc1
    buffer_store_dwordx4 v[148:151], v62, s[16:19], s54 offen sc1
    s_mov_b32 s34, 16384
    s_waitcnt vmcnt(4)
Lp0:
    v_xor_b32 v161, s8, v161
    v_xor_b32 v163, s9, v163
    v_xor_b32 v165, s8, v165
    v_xor_b32 v167, s9, v167
    v_or3_b32 v161, v161, v165, v167
    v_xor_b32 v169, s8, v169
    v_xor_b32 v171, s9, v171
    v_or3_b32 v161, v161, v169, v171
    v_xor_b32 v173, s8, v173
    v_xor_b32 v175, s9, v175
    v_or3_b32 v161, v161, v173, v175
    v_xor_b32 v177, s8, v177
    v_xor_b32 v179, s9, v179
    v_or3_b32 v161, v161, v177, v179
    v_xor_b32 v181, s8, v181
    v_xor_b32 v183, s9, v183
    v_or3_b32 v161, v161, v181, v183
    v_xor_b32 v185, s8, v185
    v_xor_b32 v187, s9, v187
    v_or3_b32 v161, v161, v185, v187
    v_xor_b32 v189, s8, v189
    v_xor_b32 v191, s9, v191
    v_or3_b32 v161, v161, v189, v191
    v_xor_b32 v193, v68, v193
    v_xor_b32 v195, v68, v195
    v_xor_b32 v197, v68, v197
    v_xor_b32 v199, v68, v199
    v_or3_b32 v161, v161, v163, v193
    v_or3_b32 v195, v195, v197, v199
    v_or_b32 v161, v161, v195
    v_cmp_ne_u32 vcc, 0, v161
    s_nop 0
    s_cmp_eq_u64 vcc, 0
    s_cbranch_scc1 Lp0_x
    buffer_load_dwordx4 v[160:163], v63, s[16:19], s56 offen sc1
    buffer_load_dwordx4 v[176:179], v59, s[16:19], s56 offen sc1
    buffer_load_dwordx2 v[192:193], v60, s[16:19], s56 offen sc1
    buffer_load_dwordx4 v[164:167], v63, s[16:19], s57 offen sc1
    buffer_load_dwordx4 v[180:183], v59, s[16:19], s57 offen sc1
    buffer_load_dwordx2 v[194:195], v60, s[16:19], s57 offen sc1
    buffer_load_dwordx4 v[168:171], v63, s[16:19], s58 offen sc1
    buffer_load_dwordx4 v[184:187], v59, s[16:19], s58 offen sc1
    buffer_load_dwordx2 v[196:197], v60, s[16:19], s58 offen sc1
    buffer_load_dwordx4 v[172:175], v63, s[16:19], s59 offen sc1
    buffer_load_dwordx4 v[188:191], v59, s[16:19], s59 offen sc1
    buffer_load_dwordx2 v[198:199], v60, s[16:19], s59 offen sc1
    s_waitcnt vmcnt(0)
    s_sub_u32 s34, s34, 1
    s_cbranch_scc0 Lp0
Lp0_x:
    v_add_f32 v160, v160, v164
    v_add_f32 v168, v168, v172
    v_add_f32 v162, v162, v166
    v_add_f32 v170, v170, v174
    v_add_f32 v176, v176, v180
    v_add_f32 v184, v184, v188
    v_add_f32 v178, v178, v182
    v_add_f32 v186, v186, v190
    v_add_f32 v192, v192, v194
    v_add_f32 v196, v196, v198
    v_add_f32 v160, v160, v168
    v_add_f32 v162, v162, v170
    v_add_f32 v176, v176, v184
    v_add_f32 v178, v178, v186
    v_add_f32 v192, v192, v196
    v_cvt_pk_bf16_f32 v160, v160, v162
    v_cvt_pk_bf16_f32 v176, v176, v178
    v_cvt_pk_bf16_f32 v192, v192, v192
    v_and_b32 v161, s13, v160
    v_lshlrev_b32 v160, 16, v160
    ds_write_b64 v58, v[160:161]
    v_and_b32 v177, s13, v176
    v_lshlrev_b32 v176, 16, v176
    v_and_b32 v192, s13, v192
    v_add_f32 v176, s49, v176
    v_add_f32 v177, s49, v177
    v_add_f32 v192, 1.0, v192
    v_cvt_pk_bf16_f32 v176, v176, v177
    v_cvt_pk_bf16_f32 v192, v192, v192
    v_and_b32 v177, s13, v176
    v_lshlrev_b32 v176, 16, v176
    v_and_b32 v192, s13, v192
    ds_write_b64 v58, v[176:177] offset:2048
    ds_write_b32 v69, v192
    buffer_store_dwordx4 v[156:159], v220, s[16:19], s62 offen offset:0 sc1
    s_waitcnt lgkmcnt(0)
    s_barrier
    ds_read_b64 v[52:53], v243 offset:2560
    ds_read_b64 v[62:63], v243 offset:0
    ds_read_b64 v[54:55], v243 offset:2568
    ds_read_b64 v[64:65], v243 offset:8
    ds_read_b64 v[56:57], v243 offset:2576
    ds_read_b64 v[66:67], v243 offset:16
    ds_read_b64 v[58:59], v243 offset:2584
    ds_read_b64 v[68:69], v243 offset:24
    buffer_store_dwordx4 v[156:159], v220, s[16:19], s62 offen offset:1024 sc1
    ds_read_b64 v[60:61], v243 offset:2592
    ds_read_b64 v[70:71], v243 offset:32
    s_waitcnt lgkmcnt(8)
    v_pk_fma_f32 v[120:121], v[120:121], v[52:53], v[62:63] op_sel:[0,0,0] op_sel_hi:[1,0,0]
    v_cvt_pk_bf16_f32 v120, v120, v121
    ds_write_b32 v232, v120 offset:0
    v_pk_fma_f32 v[122:123], v[122:123], v[52:53], v[62:63] op_sel:[0,1,1] op_sel_hi:[1,1,1]
    v_cvt_pk_bf16_f32 v122, v122, v123
    ds_write_b32 v232, v122 offset:144
    s_waitcnt lgkmcnt(8)
    v_pk_fma_f32 v[124:125], v[124:125], v[54:55], v[64:65] op_sel:[0,0,0] op_sel_hi:[1,0,0]
    buffer_store_dwordx4 v[156:159], v220, s[16:19], s62 offen offset:2048 sc1
    v_cvt_pk_bf16_f32 v124, v124, v125
    ds_write_b32 v232, v124 offset:288
    v_pk_fma_f32 v[126:127], v[126:127], v[54:55], v[64:65] op_sel:[0,1,1] op_sel_hi:[1,1,1]
    v_cvt_pk_bf16_f32 v126, v126, v127
    ds_write_b32 v232, v126 offset:432
    s_waitcnt lgkmcnt(8)
    v_pk_fma_f32 v[128:129], v[128:129], v[56:57], v[66:67] op_sel:[0,0,0] op_sel_hi:[1,0,0]
    v_cvt_pk_bf16_f32 v128, v128, v129
    ds_write_b32 v232, v128 offset:576
    v_pk_fma_f32 v[130:131], v[130:131], v[56:57], v[66:67] op_sel:[0,1,1] op_sel_hi:[1,1,1]
    buffer_store_dwordx4 v[156:159], v221, s[16:19], s40 offen sc1
    v_cvt_pk_bf16_f32 v130, v130, v131
    ds_write_b32 v232, v130 offset:720
    s_waitcnt lgkmcnt(8)
    v_pk_fma_f32 v[132:133], v[132:133], v[58:59], v[68:69] op_sel:[0,0,0] op_sel_hi:[1,0,0]
    v_cvt_pk_bf16_f32 v132, v132, v133
    ds_write_b32 v232, v132 offset:864
    v_pk_fma_f32 v[134:135], v[134:135], v[58:59], v[68:69] op_sel:[0,1,1] op_sel_hi:[1,1,1]
    v_cvt_pk_bf16_f32 v134, v134, v135
    ds_write_b32 v232, v134 offset:1008
    s_waitcnt lgkmcnt(8)
    v_pk_fma_f32 v[136:137], v[136:137], v[60:61], v[70:71] op_sel:[0,0,0] op_sel_hi:[1,0,0]
    s_add_u32 m0, s55, 62688
    s_nop 0
    buffer_load_dwordx4 v252, s[28:31], s39 offen lds
    v_cvt_pk_bf16_f32 v136, v136, v137
    ds_write_b32 v232, v136 offset:1152
    v_pk_fma_f32 v[138:139], v[138:139], v[60:61], v[70:71] op_sel:[0,1,1] op_sel_hi:[1,1,1]
    v_cvt_pk_bf16_f32 v138, v138, v139
    ds_write_b32 v232, v138 offset:1296
    s_waitcnt lgkmcnt(0)
    ds_read_b128 v[140:143], v233 offset:0
    ds_read_b128 v[144:147], v233 offset:32
    ds_read_b128 v[148:151], v233 offset:64
    ds_read_b128 v[152:155], v233 offset:96
    buffer_load_dwordx4 v253, s[28:31], s39 offen offset:1024 lds
    s_waitcnt lgkmcnt(3)
    v_mfma_f32_32x32x16_bf16 v[160:175], v[140:143], v[8:11], 0
    v_mfma_f32_32x32x16_bf16 v[176:191], v[140:143], v[24:27], 0
    s_add_u32 s39, s39, 30720
    s_add_u32 m0, s55, 64640
    s_nop 0
    buffer_load_dwordx4 v252, s[28:31], s39 offen lds
    s_waitcnt lgkmcnt(2)
    v_mfma_f32_32x32x16_bf16 v[160:175], v[144:147], v[12:15], v[160:175]
    v_mfma_f32_32x32x16_bf16 v[176:191], v[144:147], v[28:31], v[176:191]
    buffer_load_dwordx4 v253, s[28:31], s39 offen offset:1024 lds
    s_waitcnt lgkmcnt(1)
    v_mfma_f32_32x32x16_bf16 v[160:175], v[148:151], v[16:19], v[160:175]
    v_mfma_f32_32x32x16_bf16 v[176:191], v[148:151], v[32:35], v[176:191]
    s_add_u32 s39, s39, 30720
    s_add_u32 m0, s55, 66592
    s_nop 0
    buffer_load_dwordx4 v252, s[28:31], s39 offen lds
    s_waitcnt lgkmcnt(0)
    v_mfma_f32_32x32x16_bf16 v[160:175], v[152:155], v[20:23], v[160:175]
    v_mfma_f32_32x32x16_bf16 v[176:191], v[152:155], v[36:39], v[176:191]
    buffer_load_dwordx4 v253, s[28:31], s39 offen offset:1024 lds
    s_nop 9
    v_pk_mul_f32 v[120:121], v[160:161], v[96:97]
    v_pk_mul_f32 v[130:131], v[160:161], v[106:107] neg_lo:[1,0] neg_hi:[1,0]
    v_pk_mul_f32 v[122:123], v[162:163], v[98:99]
    v_pk_mul_f32 v[132:133], v[162:163], v[108:109] neg_lo:[1,0] neg_hi:[1,0]
    v_pk_mul_f32 v[124:125], v[164:165], v[100:101]
    v_pk_mul_f32 v[134:135], v[164:165], v[110:111] neg_lo:[1,0] neg_hi:[1,0]
    v_pk_mul_f32 v[126:127], v[166:167], v[102:103]
    v_pk_mul_f32 v[136:137], v[166:167], v[112:113] neg_lo:[1,0] neg_hi:[1,0]
    v_pk_mul_f32 v[128:129], v[168:169], v[104:105]
    v_pk_mul_f32 v[138:139], v[168:169], v[114:115] neg_lo:[1,0] neg_hi:[1,0]
    s_mov_b32 s32, 262144
    buffer_load_dwordx2 v[200:201], v5, s[16:19], s32 offen sc1
    v_pk_fma_f32 v[120:121], v[176:177], v[106:107], v[120:121]
    v_pk_fma_f32 v[130:131], v[176:177], v[96:97], v[130:131]
    v_cvt_pk_bf16_f32 v208, v120, v130
    v_cvt_pk_bf16_f32 v209, v121, v131
    v_pk_fma_f32 v[122:123], v[178:179], v[108:109], v[122:123]
    v_pk_fma_f32 v[132:133], v[178:179], v[98:99], v[132:133]
    v_cvt_pk_bf16_f32 v210, v122, v132
    v_cvt_pk_bf16_f32 v211, v123, v133
    v_pk_fma_f32 v[124:125], v[180:181], v[110:111], v[124:125]
    v_pk_fma_f32 v[134:135], v[180:181], v[100:101], v[134:135]
    s_add_u32 m0, s6, 0
    s_nop 0
    buffer_load_dwordx4 v222, s[44:47], s51 offen lds
    v_cvt_pk_bf16_f32 v212, v124, v134
    v_cvt_pk_bf16_f32 v213, v125, v135
    v_pk_fma_f32 v[126:127], v[182:183], v[112:113], v[126:127]
    v_pk_fma_f32 v[136:137], v[182:183], v[102:103], v[136:137]
    v_cvt_pk_bf16_f32 v214, v126, v136
    v_cvt_pk_bf16_f32 v215, v127, v137
    v_pk_fma_f32 v[128:129], v[184:185], v[114:115], v[128:129]
    v_pk_fma_f32 v[138:139], v[184:185], v[104:105], v[138:139]
    v_cvt_pk_bf16_f32 v216, v128, v138
    v_cvt_pk_bf16_f32 v217, v129, v139
    s_add_u32 m0, s6, 1024
    s_nop 0
    buffer_load_dwordx4 v223, s[44:47], s51 offen lds
    v_mfma_f32_32x32x16_bf16 v[160:175], v[72:75], v[208:211], 0
    v_mfma_f32_32x32x16_bf16 v[176:191], v[84:87], v[208:211], 0
    s_add_u32 m0, s6, 2048
    s_nop 0
    buffer_load_dwordx4 v224, s[44:47], s51 offen lds
    v_mfma_f32_32x32x16_bf16 v[160:175], v[76:79], v[212:215], v[160:175]
    v_mfma_f32_32x32x16_bf16 v[176:191], v[88:91], v[212:215], v[176:191]
    s_add_u32 m0, s6, 3072
    s_nop 0
    buffer_load_dwordx4 v225, s[44:47], s51 offen lds
    v_mfma_f32_32x32x16_bf16 v[160:175], v[80:83], v[216:219], v[160:175]
    v_mfma_f32_32x32x16_bf16 v[176:191], v[92:95], v[216:219], v[176:191]
    s_add_u32 m0, s6, 4096
    s_nop 0
    buffer_load_dwordx4 v226, s[44:47], s51 offen lds
    s_nop 8
    v_cvt_pk_bf16_f32 v120, v160, v176
    ds_write_b32 v234, v120 offset:0
    v_cvt_pk_bf16_f32 v121, v161, v177
    ds_write_b32 v234, v121 offset:512
    v_cvt_pk_bf16_f32 v122, v162, v178
    ds_write_b32 v234, v122 offset:1024
    v_cvt_pk_bf16_f32 v123, v163, v179
    ds_write_b32 v234, v123 offset:1536
    v_cvt_pk_bf16_f32 v124, v164, v180
    ds_write_b32 v234, v124 offset:2048
    v_cvt_pk_bf16_f32 v125, v165, v181
    ds_write_b32 v234, v125 offset:2560
    v_cvt_pk_bf16_f32 v126, v166, v182
    ds_write_b32 v234, v126 offset:3072
    v_cvt_pk_bf16_f32 v127, v167, v183
    ds_write_b32 v234, v127 offset:3584
    v_cvt_pk_bf16_f32 v128, v168, v184
    ds_write_b32 v234, v128 offset:4096
    v_cvt_pk_bf16_f32 v129, v169, v185
    ds_write_b32 v234, v129 offset:4608
    s_mov_b32 s34, 16384
    s_waitcnt vmcnt(5)
Ltka:
    v_xor_b32 v200, s8, v200
    v_xor_b32 v201, s9, v201
    v_or_b32 v200, v200, v201
    v_cmp_ne_u32 vcc, 0, v200
    s_nop 0
    s_cmp_eq_u64 vcc, 0
    s_cbranch_scc1 Ltka_x
    s_mov_b32 s32, 262144
    buffer_load_dwordx2 v[200:201], v5, s[16:19], s32 offen sc1
    s_waitcnt vmcnt(0)
    s_sub_u32 s34, s34, 1
    s_cbranch_scc0 Ltka
Ltka_x:
    s_waitcnt lgkmcnt(0)
    s_barrier
    ds_read_b128 v[140:143], v235
    ds_read_b128 v[144:147], v236
    ds_read_b128 v[148:151], v237
    s_waitcnt lgkmcnt(2)
    v_mfma_f32_32x32x16_bf16 v[160:175], v[116:119], v[140:143], 0
    s_waitcnt lgkmcnt(1)
    v_mfma_f32_32x32x16_bf16 v[176:191], v[116:119], v[144:147], 0
    s_waitcnt lgkmcnt(0)
    v_mfma_f32_32x32x16_bf16 v[192:207], v[116:119], v[148:151], 0
    s_nop 7
    v_cvt_pk_bf16_f32 v208, v160, v161
    v_cvt_pk_bf16_f32 v209, v162, v163
    v_cvt_pk_bf16_f32 v210, v164, v165
    v_cvt_pk_bf16_f32 v211, v166, v167
    buffer_store_dwordx4 v[208:211], v238, s[16:19], s38 offen sc1
    v_cvt_pk_bf16_f32 v212, v176, v177
    v_cvt_pk_bf16_f32 v213, v178, v179
    v_cvt_pk_bf16_f32 v214, v180, v181
    v_cvt_pk_bf16_f32 v215, v182, v183
    s_add_u32 s38, s38, 4096
    buffer_store_dwordx4 v[212:215], v238, s[16:19], s38 offen sc1
    v_cvt_pk_bf16_f32 v216, v192, v193
    v_cvt_pk_bf16_f32 v217, v194, v195
    v_cvt_pk_bf16_f32 v218, v196, v197
    v_cvt_pk_bf16_f32 v219, v198, v199
    s_add_u32 s38, s38, 4096
    buffer_store_dwordx4 v[216:219], v239, s[16:19], s38 offen sc1
    v_bfe_u32 v220, v1, 2, 2
    v_lshrrev_b32 v221, 4, v1
    v_lshl_add_u32 v220, v221, 3, v220
    v_mul_u32_u24 v220, 160, v220
    v_and_b32 v221, 3, v1
    v_mul_u32_u24 v221, 40, v221
    s_and_b32 s35, s3, 1
    s_mul_i32 s35, s35, 5120
    s_add_u32 s35, s35, 153600
    v_add3_u32 v220, v220, v221, s35
    s_cmp_eq_u32 s46, 0
    s_cselect_b32 s35, 1073741824, 0
    v_add_u32 v221, s35, v2
    s_and_b32 s44, s14, 7
    s_mul_i32 s44, s44, 245760
    s_lshr_b32 s35, s14, 3
    s_mul_i32 s35, s35, 5120
    s_add_u32 s44, s44, s35
    s_add_u32 s44, s44, 23068672
    s_add_u32 s45, s44, 4096
    s_waitcnt vmcnt(3)
    ds_read_b64_tr_b16 v[192:193], v220 offset:0
    ds_read_b64_tr_b16 v[194:195], v220 offset:640
    ds_read_b64_tr_b16 v[196:197], v220 offset:8
    ds_read_b64_tr_b16 v[198:199], v220 offset:648
    ds_read_b64_tr_b16 v[200:201], v220 offset:16
    ds_read_b64_tr_b16 v[202:203], v220 offset:656
    ds_read_b64_tr_b16 v[204:205], v220 offset:24
    ds_read_b64_tr_b16 v[206:207], v220 offset:664
    ds_read_b64_tr_b16 v[208:209], v220 offset:32
    ds_read_b64_tr_b16 v[210:211], v220 offset:672
    s_waitcnt lgkmcnt(0)
    buffer_store_dwordx4 v[192:195], v221, s[16:19], s44 offen offset:0 sc1
    buffer_store_dwordx4 v[196:199], v221, s[16:19], s44 offen offset:1024 sc1
    buffer_store_dwordx4 v[200:203], v221, s[16:19], s44 offen offset:2048 sc1
    buffer_store_dwordx4 v[204:207], v221, s[16:19], s44 offen offset:3072 sc1
    buffer_store_dwordx4 v[208:211], v221, s[16:19], s45 offen offset:0 sc1
    v_and_b32 v58, 15, v1
    v_lshrrev_b32 v59, 4, v1
    v_cvt_f32_u32 v58, v58
    v_cvt_f32_u32 v59, v59
    v_mul_f32 v136, 0x3d800000, v58
    v_mul_f32 v59, 4.0, v59
    v_mul_f32 v137, v59, v136
    v_cos_f32 v138, v137
    v_sin_f32 v139, v137
    v_mul_f32 v140, 0x3d800000, v137
    v_add_f32 v137, v137, v136
    v_cvt_pk_bf16_f32 v60, v138, v139
    v_cvt_pk_bf16_f32 v64, -v139, v138
    v_cos_f32 v68, v140
    s_add_u32 s39, s39, 30720
    s_add_u32 m0, s55, 68544
    s_nop 0
    buffer_load_dwordx4 v252, s[28:31], s39 offen lds
    v_sin_f32 v72, v140
    v_cos_f32 v138, v137
    v_sin_f32 v139, v137
    v_mul_f32 v140, 0x3d800000, v137
    v_add_f32 v137, v137, v136
    v_cvt_pk_bf16_f32 v61, v138, v139
    v_cvt_pk_bf16_f32 v65, -v139, v138
    v_cos_f32 v69, v140
    v_sin_f32 v73, v140
    v_cos_f32 v138, v137
    buffer_load_dwordx4 v253, s[28:31], s39 offen offset:1024 lds
    v_sin_f32 v139, v137
    v_mul_f32 v140, 0x3d800000, v137
    v_add_f32 v137, v137, v136
    v_cvt_pk_bf16_f32 v62, v138, v139
    v_cvt_pk_bf16_f32 v66, -v139, v138
    v_cos_f32 v70, v140
    v_sin_f32 v74, v140
    v_cos_f32 v138, v137
    v_sin_f32 v139, v137
    v_mul_f32 v140, 0x3d800000, v137
    v_add_f32 v137, v137, v136
    s_add_u32 s39, s39, 30720
    s_add_u32 m0, s55, 70496
    s_nop 0
    buffer_load_dwordx4 v252, s[28:31], s39 offen lds
    v_cvt_pk_bf16_f32 v63, v138, v139
    v_cvt_pk_bf16_f32 v67, -v139, v138
    v_cos_f32 v71, v140
    v_sin_f32 v75, v140
    s_mul_i32 s35, s3, 192
    v_add_u32 v136, s35, v1
    v_mul_u32_u24 v137, 43691, v136
    v_lshrrev_b32 v137, 17, v137
    v_mul_u32_u24 v138, 3, v137
    v_sub_u32 v138, v136, v138
    v_mul_u32_u24 v55, 4144, v138
    v_lshl_add_u32 v55, v137, 2, v55
    v_add_u32 v55, 140800, v55
    v_and_b32 v139, 0xc0, v137
    buffer_load_dwordx4 v253, s[28:31], s39 offen offset:1024 lds
    v_and_b32 v140, 3, v137
    v_lshl_add_u32 v139, v140, 4, v139
    v_bfe_u32 v140, v137, 2, 4
    v_add_u32 v139, v139, v140
    v_mul_u32_u24 v139, 10368, v139
    v_lshl_add_u32 v139, v138, 4, v139
    v_mov_b32 v52, v139
    v_add_u32 v136, s35, v1
    v_add_u32 v136, 64, v136
    v_mul_u32_u24 v137, 43691, v136
    v_lshrrev_b32 v137, 17, v137
    v_mul_u32_u24 v138, 3, v137
    v_sub_u32 v138, v136, v138
    v_mul_u32_u24 v56, 4144, v138
    v_lshl_add_u32 v56, v137, 2, v56
    v_add_u32 v56, 140800, v56
    s_add_u32 s39, s39, 30720
    s_add_u32 m0, s55, 72448
    s_nop 0
    buffer_load_dwordx4 v252, s[28:31], s39 offen lds
    v_and_b32 v139, 0xc0, v137
    v_and_b32 v140, 3, v137
    v_lshl_add_u32 v139, v140, 4, v139
    v_bfe_u32 v140, v137, 2, 4
    v_add_u32 v139, v139, v140
    v_mul_u32_u24 v139, 10368, v139
    v_lshl_add_u32 v139, v138, 4, v139
    v_mov_b32 v53, v139
    v_add_u32 v136, s35, v1
    v_add_u32 v136, 128, v136
    v_mul_u32_u24 v137, 43691, v136
    v_lshrrev_b32 v137, 17, v137
    v_mul_u32_u24 v138, 3, v137
    v_sub_u32 v138, v136, v138
    v_mul_u32_u24 v57, 4144, v138
    v_lshl_add_u32 v57, v137, 2, v57
    buffer_load_dwordx4 v253, s[28:31], s39 offen offset:1024 lds
    v_add_u32 v57, 140800, v57
    v_and_b32 v139, 0xc0, v137
    v_and_b32 v140, 3, v137
    v_lshl_add_u32 v139, v140, 4, v139
    v_bfe_u32 v140, v137, 2, 4
    v_add_u32 v139, v139, v140
    v_mul_u32_u24 v139, 10368, v139
    v_lshl_add_u32 v139, v138, 4, v139
    v_mov_b32 v54, v139
    s_lshl_b32 s35, s3, 10
    s_add_u32 s35, s35, 140800
    v_add_u32 v58, s35, v2
    s_mul_i32 s38, s15, 48
    s_add_u32 s38, s38, 1048576
    s_mul_i32 s48, s15, 12288
    s_lshl_b32 s35, s3, 10
    s_add_u32 s48, s48, s35
    s_add_u32 s48, s48, 7340032
    s_add_u32 s49, s48, 4096
    s_add_u32 s50, s48, 8192
    v_and_b32 v136, 15, v1
    s_add_u32 s39, s39, 30720
    s_add_u32 m0, s55, 74400
    s_nop 0
    buffer_load_dwordx4 v252, s[28:31], s39 offen lds
    v_lshlrev_b32 v136, 4, v136
    v_mul_u32_u24 v239, 5120, v4
    v_bfe_u32 v137, v1, 4, 1
    v_mul_u32_u24 v137, 3145728, v137
    v_add3_u32 v239, v239, v136, v137
    v_add_u32 v234, s63, v2
    v_lshrrev_b32 v136, 4, v1
    v_bfe_u32 v137, v1, 2, 2
    v_and_b32 v138, 3, v1
    s_mul_i32 s35, s3, 48
    s_add_u32 s35, s35, 62688
    v_lshl_add_u32 v254, v138, 3, s35
    v_lshrrev_b32 v139, 1, v138
    v_mul_u32_u24 v139, 31328, v139
    v_add3_u32 v205, v254, v139, 32
    v_mul_u32_u24 v136, 1952, v136
    buffer_load_dwordx4 v253, s[28:31], s39 offen offset:1024 lds
    v_mul_u32_u24 v138, 192, v137
    v_lshrrev_b32 v139, 1, v137
    v_mul_u32_u24 v139, 1568, v139
    v_add_u32 v138, v138, v136
    v_add3_u32 v139, v139, v138, v136
    v_add_u32 v139, 1536, v139
    v_add_u32 v211, v254, v139
    v_add_u32 v222, v205, v139
    v_add_u32 v254, v254, v138
    v_add_u32 v205, v205, v138
    s_add_u32 s39, s39, 30720
    s_add_u32 m0, s55, 76352
    s_nop 0
    buffer_load_dwordx4 v252, s[28:31], s39 offen lds
    buffer_load_dwordx4 v253, s[28:31], s39 offen offset:1024 lds
    s_waitcnt vmcnt(15) lgkmcnt(0)
    buffer_load_dwordx4 v[40:43], v52, s[16:19], s38 offen sc1
    buffer_load_dwordx4 v[44:47], v53, s[16:19], s38 offen sc1
    buffer_load_dwordx4 v[48:51], v54, s[16:19], s38 offen sc1
    v_mov_b32 v236, v240
    v_mov_b32 v237, v241
    v_mov_b32 v235, v242
    v_cmp_eq_u32 vcc, 0, v4
    v_bfe_u32 v140, v3, 1, 1
    v_bfe_u32 v141, v3, 3, 1
    v_lshl_add_u32 v140, v141, 1, v140
    v_lshl_add_u32 v140, v140, 8, s12
    v_cvt_f32_u32 v140, v140
    v_mul_f32 v140, 0x3a000000, v140
    v_bfe_u32 v141, v3, 2, 1
    v_cvt_f32_u32 v141, v141
    v_mov_b32 v142, 0xbe800000
    v_fmaak_f32 v141, v142, v141, 0x3e000000
    v_and_b32 v142, 1, v3
    v_cvt_f32_u32 v142, v142
    v_mul_f32 v142, v142, v141
    v_mul_f32 v142, -2.0, v142
    v_cvt_f32_u32 v147, v4
    v_mul_f32 v147, 4.0, v147
    v_fma_f32 v142, v147, v140, v142
    v_add_f32 v143, v142, v141
    v_cos_f32 v144, v143
    v_sin_f32 v145, v143
    v_add_f32 v142, v142, v140
    v_cvt_pk_bf16_f32 v132, v144, -v145
    v_sub_f32 v143, v142, v141
    v_cos_f32 v144, v143
    v_sin_f32 v145, v143
    v_add_f32 v142, v142, v140
    v_cvt_pk_bf16_f32 v133, v144, -v145
    v_add_f32 v143, v142, v141
    v_cos_f32 v144, v143
    v_sin_f32 v145, v143
    v_add_f32 v142, v142, v140
    v_cvt_pk_bf16_f32 v134, v144, -v145
    v_sub_f32 v143, v142, v141
    v_cos_f32 v144, v143
    v_sin_f32 v145, v143
    v_add_f32 v142, v142, v140
    v_cvt_pk_bf16_f32 v135, v144, -v145
    v_and_b32 v140, 3, v3
    v_lshrrev_b32 v141, 3, v3
    v_lshl_add_u32 v140, v141, 2, v140
    v_min_u32 v140, 9, v140
    v_bfe_u32 v141, v3, 2, 1
    v_mad_u32_u24 v140, v141, 10, v140
    v_cvt_f32_u32 v140, v140
    v_mul_f32 v140, 0x3d4ccccd, v140
    v_mul_f32 v141, 4.0, v140
    v_mul_f32 v142, v147, v140
    v_mul_f32 v146, 0x41200000, v140
    v_cos_f32 v144, v142
    v_sin_f32 v145, v142
    v_add_f32 v142, v142, v140
    v_cvt_pk_bf16_f32 v76, v144, -v145
    v_cvt_pk_bf16_f32 v88, v145, v144
    v_cos_f32 v144, v142
    v_sin_f32 v145, v142
    v_add_f32 v142, v142, v140
    v_cvt_pk_bf16_f32 v77, v144, -v145
    v_cvt_pk_bf16_f32 v89, v145, v144
    v_cos_f32 v144, v142
    v_sin_f32 v145, v142
    v_add_f32 v142, v142, v140
    v_cvt_pk_bf16_f32 v78, v144, -v145
    v_cvt_pk_bf16_f32 v90, v145, v144
    v_cos_f32 v144, v142
    v_sin_f32 v145, v142
    v_add_f32 v142, v142, v140
    v_add_f32 v142, v142, v141
    v_cvt_pk_bf16_f32 v79, v144, -v145
    v_cvt_pk_bf16_f32 v91, v145, v144
    v_cos_f32 v144, v142
    v_sin_f32 v145, v142
    v_add_f32 v142, v142, v140
    v_cvt_pk_bf16_f32 v80, v144, -v145
    v_cvt_pk_bf16_f32 v92, v145, v144
    v_cos_f32 v144, v142
    v_sin_f32 v145, v142
    v_add_f32 v142, v142, v140
    v_cvt_pk_bf16_f32 v81, v144, -v145
    v_cvt_pk_bf16_f32 v93, v145, v144
    v_cos_f32 v144, v142
    v_sin_f32 v145, v142
    v_add_f32 v142, v142, v140
    v_cvt_pk_bf16_f32 v82, v144, -v145
    v_cvt_pk_bf16_f32 v94, v145, v144
    v_cos_f32 v144, v142
    v_sin_f32 v145, v142
    v_add_f32 v142, v142, v140
    v_add_f32 v142, v142, v141
    v_cvt_pk_bf16_f32 v83, v144, -v145
    v_cvt_pk_bf16_f32 v95, v145, v144
    v_cos_f32 v144, v142
    v_sin_f32 v145, v142
    v_add_f32 v142, v142, v140
    v_cvt_pk_bf16_f32 v84, v144, -v145
    v_cvt_pk_bf16_f32 v96, v145, v144
    v_cndmask_b32 v143, v146, v142, vcc
    v_cos_f32 v144, v143
    v_sin_f32 v145, v143
    v_add_f32 v142, v142, v140
    v_cvt_pk_bf16_f32 v85, v144, -v145
    v_cvt_pk_bf16_f32 v97, v145, v144
    v_cos_f32 v144, v142
    v_sin_f32 v145, v142
    v_add_f32 v142, v142, v140
    v_cvt_pk_bf16_f32 v86, v144, -v145
    v_cvt_pk_bf16_f32 v98, v145, v144
    v_cos_f32 v144, v142
    v_sin_f32 v145, v142
    v_add_f32 v142, v142, v140
    v_add_f32 v142, v142, v141
    v_cvt_pk_bf16_f32 v87, v144, -v145
    v_cvt_pk_bf16_f32 v99, v145, v144
    v_mul_f32 v140, 0x3d000000, v140
    v_mul_f32 v141, 4.0, v140
    v_mul_f32 v142, v147, v140
    v_cos_f32 v100, v142
    v_sin_f32 v116, v142
    v_add_f32 v142, v142, v140
    v_cos_f32 v101, v142
    v_sin_f32 v117, v142
    v_add_f32 v142, v142, v140
    v_cos_f32 v102, v142
    v_sin_f32 v118, v142
    v_add_f32 v142, v142, v140
    v_cos_f32 v103, v142
    v_sin_f32 v119, v142
    v_add_f32 v142, v142, v140
    v_add_f32 v142, v142, v141
    v_cos_f32 v104, v142
    v_sin_f32 v120, v142
    v_add_f32 v142, v142, v140
    v_cos_f32 v105, v142
    v_sin_f32 v121, v142
    v_add_f32 v142, v142, v140
    v_cos_f32 v106, v142
    v_sin_f32 v122, v142
    v_add_f32 v142, v142, v140
    v_cos_f32 v107, v142
    v_sin_f32 v123, v142
    v_add_f32 v142, v142, v140
    v_add_f32 v142, v142, v141
    v_cos_f32 v108, v142
    v_sin_f32 v124, v142
    v_add_f32 v142, v142, v140
    v_cos_f32 v109, v142
    v_sin_f32 v125, v142
    v_add_f32 v142, v142, v140
    v_cos_f32 v110, v142
    v_sin_f32 v126, v142
    v_add_f32 v142, v142, v140
    v_cos_f32 v111, v142
    v_sin_f32 v127, v142
    v_add_f32 v142, v142, v140
    v_add_f32 v142, v142, v141
    v_cos_f32 v112, v142
    v_sin_f32 v128, v142
    v_add_f32 v142, v142, v140
    v_cos_f32 v113, v142
    v_sin_f32 v129, v142
    v_add_f32 v142, v142, v140
    v_cos_f32 v114, v142
    v_sin_f32 v130, v142
    v_add_f32 v142, v142, v140
    v_cos_f32 v115, v142
    v_sin_f32 v131, v142
    v_add_f32 v142, v142, v140
    v_add_f32 v142, v142, v141
    v_accvgpr_write_b32 a144, v76
    v_accvgpr_write_b32 a145, v77
    v_accvgpr_write_b32 a146, v78
    v_accvgpr_write_b32 a147, v79
    v_accvgpr_write_b32 a148, v80
    v_accvgpr_write_b32 a149, v81
    v_accvgpr_write_b32 a150, v82
    v_accvgpr_write_b32 a151, v83
    v_accvgpr_write_b32 a152, v84
    v_accvgpr_write_b32 a153, v85
    v_accvgpr_write_b32 a154, v86
    v_accvgpr_write_b32 a155, v87
    v_accvgpr_write_b32 a156, v88
    v_accvgpr_write_b32 a157, v89
    v_accvgpr_write_b32 a158, v90
    v_accvgpr_write_b32 a159, v91
    v_accvgpr_write_b32 a160, v92
    v_accvgpr_write_b32 a161, v93
    v_accvgpr_write_b32 a162, v94
    v_accvgpr_write_b32 a163, v95
    v_accvgpr_write_b32 a164, v96
    v_accvgpr_write_b32 a165, v97
    v_accvgpr_write_b32 a166, v98
    v_accvgpr_write_b32 a167, v99
    v_accvgpr_write_b32 a168, v132
    v_accvgpr_write_b32 a169, v133
    v_accvgpr_write_b32 a170, v134
    v_accvgpr_write_b32 a171, v135
    v_accvgpr_write_b32 a96, v100
    v_accvgpr_write_b32 a97, v101
    v_accvgpr_write_b32 a98, v102
    v_accvgpr_write_b32 a99, v103
    v_accvgpr_write_b32 a100, v104
    v_accvgpr_write_b32 a101, v105
    v_accvgpr_write_b32 a102, v106
    v_accvgpr_write_b32 a103, v107
    v_accvgpr_write_b32 a104, v108
    v_accvgpr_write_b32 a105, v109
    v_accvgpr_write_b32 a106, v110
    v_accvgpr_write_b32 a107, v111
    v_accvgpr_write_b32 a108, v112
    v_accvgpr_write_b32 a109, v113
    v_accvgpr_write_b32 a110, v114
    v_accvgpr_write_b32 a111, v115
    v_accvgpr_write_b32 a112, v116
    v_accvgpr_write_b32 a113, v117
    v_accvgpr_write_b32 a114, v118
    v_accvgpr_write_b32 a115, v119
    v_accvgpr_write_b32 a116, v120
    v_accvgpr_write_b32 a117, v121
    v_accvgpr_write_b32 a118, v122
    v_accvgpr_write_b32 a119, v123
    v_accvgpr_write_b32 a120, v124
    v_accvgpr_write_b32 a121, v125
    v_accvgpr_write_b32 a122, v126
    v_accvgpr_write_b32 a123, v127
    v_accvgpr_write_b32 a124, v128
    v_accvgpr_write_b32 a125, v129
    v_accvgpr_write_b32 a126, v130
    v_accvgpr_write_b32 a127, v131
    s_mov_b32 s34, 16384
    s_waitcnt vmcnt(0)
Lp1:
    v_max3_u32 v136, v40, v41, v42
    v_max3_u32 v136, v136, v43, v44
    v_max3_u32 v136, v136, v45, v46
    v_max3_u32 v136, v136, v47, v48
    v_max3_u32 v136, v136, v49, v50
    v_max_u32 v136, v136, v51
    v_cmp_eq_u32 vcc, -1, v136
    s_nop 0
    s_cmp_eq_u64 vcc, 0
    s_cbranch_scc1 Lp1_x
    buffer_load_dwordx4 v[40:43], v52, s[16:19], s38 offen sc1
    buffer_load_dwordx4 v[44:47], v53, s[16:19], s38 offen sc1
    buffer_load_dwordx4 v[48:51], v54, s[16:19], s38 offen sc1
    s_waitcnt vmcnt(0)
    s_sub_u32 s34, s34, 1
    s_cbranch_scc0 Lp1
Lp1_x:
    ds_write_b32 v55, v40 offset:0
    ds_write_b32 v55, v41 offset:1024
    ds_write_b32 v55, v42 offset:2048
    ds_write_b32 v55, v43 offset:3072
    ds_write_b32 v56, v44 offset:0
    ds_write_b32 v56, v45 offset:1024
    ds_write_b32 v56, v46 offset:2048
    ds_write_b32 v56, v47 offset:3072
    ds_write_b32 v57, v48 offset:0
    ds_write_b32 v57, v49 offset:1024
    ds_write_b32 v57, v50 offset:2048
    ds_write_b32 v57, v51 offset:3072
    v_lshlrev_b32 v188, 4, v0
    v_add_u32 v189, 4096, v188
    v_lshrrev_b32 v232, 1, v188
    v_add_u32 v232, 8192, v232
    s_waitcnt lgkmcnt(0)
    s_barrier
    buffer_load_dwordx4 v[240:243], v2, s[16:19], s48 offen sc1
    buffer_load_dwordx4 v[244:247], v2, s[16:19], s49 offen sc1
    buffer_load_dwordx4 v[248:251], v2, s[16:19], s50 offen sc1
    ds_read_b128 v[100:103], v58 offset:0
    ds_read_b128 v[104:107], v58 offset:4144
    ds_read_b128 v[108:111], v58 offset:8288
    s_mov_b32 s35, 327680
    s_mov_b64 exec, 1
    buffer_atomic_swap_x2 v[236:237], v235, s[16:19], s35 offen sc1
    s_mov_b64 exec, -1
    v_mul_u32_u24 v190, 10923, v1
    v_lshrrev_b32 v190, 16, v190
    v_mul_u32_u24 v190, 2304, v190
    v_lshl_add_u32 v190, v1, 7, v190
    s_and_b32 s32, s3, 1
    s_lshl_b32 s32, s32, 30
    v_add_u32 v190, s32, v190
    s_mul_i32 s35, s61, 30720
    s_andn2_b32 s32, s11, 3
    s_mul_i32 s32, s32, 192
    s_add_u32 s35, s35, s32
    s_add_u32 s35, s35, 983040
    buffer_load_dword v255, v190, s[28:31], s35 offen
    s_waitcnt lgkmcnt(2)
    v_mfma_f32_16x16x32_bf16 v[112:115], v[100:103], v[60:63], 0
    v_mfma_f32_16x16x32_bf16 v[124:127], v[100:103], v[64:67], 0
    s_waitcnt lgkmcnt(1)
    v_mfma_f32_16x16x32_bf16 v[116:119], v[104:107], v[60:63], 0
    v_mfma_f32_16x16x32_bf16 v[128:131], v[104:107], v[64:67], 0
    s_waitcnt lgkmcnt(0)
    v_mfma_f32_16x16x32_bf16 v[120:123], v[108:111], v[60:63], 0
    v_mfma_f32_16x16x32_bf16 v[132:135], v[108:111], v[64:67], 0
    s_nop 0
    v_pk_mul_f32 v[136:137], v[112:113], v[68:69]
    s_add_u32 s39, s39, 276480
    s_add_u32 m0, s55, 0
    s_nop 0
    buffer_load_dwordx4 v252, s[28:31], s39 offen lds
    v_pk_mul_f32 v[148:149], v[124:125], v[68:69]
    v_pk_mul_f32 v[138:139], v[114:115], v[70:71]
    v_pk_mul_f32 v[150:151], v[126:127], v[70:71]
    v_pk_fma_f32 v[136:137], v[124:125], v[72:73], v[136:137]
    ds_read_b64_tr_b16 a[0:1], v254 offset:0
    v_pk_fma_f32 v[148:149], v[112:113], v[72:73], v[148:149] neg_lo:[1,0,0] neg_hi:[1,0,0]
    v_pk_fma_f32 v[138:139], v[126:127], v[74:75], v[138:139]
    v_pk_fma_f32 v[150:151], v[114:115], v[74:75], v[150:151] neg_lo:[1,0,0] neg_hi:[1,0,0]
    v_cvt_pk_bf16_f32 v160, v136, v148
    ds_read_b64_tr_b16 a[2:3], v254 offset:768
    v_cvt_pk_bf16_f32 v161, v137, v149
    v_cvt_pk_bf16_f32 v162, v138, v150
    v_cvt_pk_bf16_f32 v163, v139, v151
    v_pk_mul_f32 v[140:141], v[116:117], v[68:69]
    buffer_load_dwordx4 v253, s[28:31], s39 offen offset:1024 lds
    v_pk_mul_f32 v[152:153], v[128:129], v[68:69]
    v_pk_mul_f32 v[142:143], v[118:119], v[70:71]
    v_pk_mul_f32 v[154:155], v[130:131], v[70:71]
    v_pk_fma_f32 v[140:141], v[128:129], v[72:73], v[140:141]
    ds_read_b64_tr_b16 a[4:5], v254 offset:31344
    v_pk_fma_f32 v[152:153], v[116:117], v[72:73], v[152:153] neg_lo:[1,0,0] neg_hi:[1,0,0]
    v_pk_fma_f32 v[142:143], v[130:131], v[74:75], v[142:143]
    v_pk_fma_f32 v[154:155], v[118:119], v[74:75], v[154:155] neg_lo:[1,0,0] neg_hi:[1,0,0]
    v_cvt_pk_bf16_f32 v164, v140, v152
    ds_read_b64_tr_b16 a[6:7], v254 offset:32112
    v_cvt_pk_bf16_f32 v165, v141, v153
    v_cvt_pk_bf16_f32 v166, v142, v154
    v_cvt_pk_bf16_f32 v167, v143, v155
    v_pk_mul_f32 v[144:145], v[120:121], v[68:69]
    s_add_u32 s39, s39, 30720
    s_add_u32 m0, s55, 1952
    s_nop 0
    buffer_load_dwordx4 v252, s[28:31], s39 offen lds
    v_pk_mul_f32 v[156:157], v[132:133], v[68:69]
    v_pk_mul_f32 v[146:147], v[122:123], v[70:71]
    v_pk_mul_f32 v[158:159], v[134:135], v[70:71]
    v_pk_fma_f32 v[144:145], v[132:133], v[72:73], v[144:145]
    ds_read_b64_tr_b16 a[8:9], v205 offset:0
    v_pk_fma_f32 v[156:157], v[120:121], v[72:73], v[156:157] neg_lo:[1,0,0] neg_hi:[1,0,0]
    v_pk_fma_f32 v[146:147], v[134:135], v[74:75], v[146:147]
    v_pk_fma_f32 v[158:159], v[122:123], v[74:75], v[158:159] neg_lo:[1,0,0] neg_hi:[1,0,0]
    v_cvt_pk_bf16_f32 v168, v144, v156
    ds_read_b64_tr_b16 a[10:11], v205 offset:768
    v_cvt_pk_bf16_f32 v169, v145, v157
    v_cvt_pk_bf16_f32 v170, v146, v158
    v_cvt_pk_bf16_f32 v171, v147, v159
    v_mfma_f32_16x16x32_bf16 v[112:115], v[60:63], v[160:163], 0
    buffer_load_dwordx4 v253, s[28:31], s39 offen offset:1024 lds
    v_mfma_f32_16x16x32_bf16 v[124:127], v[64:67], v[160:163], 0
    v_mfma_f32_16x16x32_bf16 v[116:119], v[60:63], v[164:167], 0
    ds_read_b64_tr_b16 a[12:13], v254 offset:7808
    v_mfma_f32_16x16x32_bf16 v[128:131], v[64:67], v[164:167], 0
    v_mfma_f32_16x16x32_bf16 v[120:123], v[60:63], v[168:171], 0
    ds_read_b64_tr_b16 a[14:15], v254 offset:8576
    v_mfma_f32_16x16x32_bf16 v[132:135], v[64:67], v[168:171], 0
    s_waitcnt vmcnt(6)
    v_lshlrev_b32 v76, 16, v240
    s_add_u32 s39, s39, 30720
    s_add_u32 m0, s55, 3904
    s_nop 0
    buffer_load_dwordx4 v252, s[28:31], s39 offen lds
    v_and_b32 v88, s13, v240
    v_lshlrev_b32 v77, 16, v241
    v_and_b32 v89, s13, v241
    v_lshlrev_b32 v78, 16, v242
    ds_read_b64_tr_b16 a[16:17], v254 offset:39152
    v_and_b32 v90, s13, v242
    v_lshlrev_b32 v79, 16, v243
    v_and_b32 v91, s13, v243
    v_lshlrev_b32 v80, 16, v244
    ds_read_b64_tr_b16 a[18:19], v254 offset:39920
    v_and_b32 v92, s13, v244
    v_lshlrev_b32 v81, 16, v245
    v_and_b32 v93, s13, v245
    v_lshlrev_b32 v82, 16, v246
    buffer_load_dwordx4 v253, s[28:31], s39 offen offset:1024 lds
    v_and_b32 v94, s13, v246
    v_lshlrev_b32 v83, 16, v247
    v_and_b32 v95, s13, v247
    v_lshlrev_b32 v84, 16, v248
    ds_read_b64_tr_b16 a[20:21], v205 offset:7808
    v_and_b32 v96, s13, v248
    v_lshlrev_b32 v85, 16, v249
    v_and_b32 v97, s13, v249
    v_lshlrev_b32 v86, 16, v250
    ds_read_b64_tr_b16 a[22:23], v205 offset:8576
    v_and_b32 v98, s13, v250
    v_lshlrev_b32 v87, 16, v251
    v_and_b32 v99, s13, v251
    s_cmp_eq_u32 s15, 0
    s_cselect_b32 s52, 0.5, 1.0
    s_cmp_eq_u32 s15, 213
    s_cselect_b32 s54, 0.5, 1.0
    s_cselect_b32 s53, 0.5, s52
    s_cmp_eq_u32 s53, 1.0
    s_cbranch_scc1 Lnosc
    v_mul_f32 v76, s52, v76
    v_mul_f32 v88, s52, v88
    v_mul_f32 v77, s52, v77
    v_mul_f32 v89, s52, v89
    v_mul_f32 v78, s52, v78
    v_mul_f32 v90, s52, v90
    v_mul_f32 v79, s52, v79
    v_mul_f32 v91, s52, v91
    v_mul_f32 v80, s53, v80
    v_mul_f32 v92, s53, v92
    v_mul_f32 v81, s53, v81
    v_mul_f32 v93, s53, v93
    v_mul_f32 v82, s53, v82
    v_mul_f32 v94, s53, v94
    v_mul_f32 v83, s53, v83
    v_mul_f32 v95, s53, v95
    v_mul_f32 v84, s54, v84
    v_mul_f32 v96, s54, v96
    v_mul_f32 v85, s54, v85
    v_mul_f32 v97, s54, v97
    v_mul_f32 v86, s54, v86
    v_mul_f32 v98, s54, v98
    v_mul_f32 v87, s54, v87
    v_mul_f32 v99, s54, v99
Lnosc:
    v_pk_mul_f32 v[136:137], v[112:113], v[76:77]
    s_add_u32 s39, s39, 30720
    s_add_u32 m0, s55, 5856
    s_nop 0
    buffer_load_dwordx4 v252, s[28:31], s39 offen lds
    v_pk_mul_f32 v[148:149], v[124:125], v[76:77]
    v_pk_mul_f32 v[138:139], v[114:115], v[78:79]
    v_pk_mul_f32 v[150:151], v[126:127], v[78:79]
    v_pk_fma_f32 v[136:137], v[124:125], v[88:89], v[136:137] neg_lo:[1,0,0] neg_hi:[1,0,0]
    ds_read_b64_tr_b16 a[24:25], v254 offset:15616
    v_pk_fma_f32 v[148:149], v[112:113], v[88:89], v[148:149]
    v_pk_fma_f32 v[138:139], v[126:127], v[90:91], v[138:139] neg_lo:[1,0,0] neg_hi:[1,0,0]
    v_pk_fma_f32 v[150:151], v[114:115], v[90:91], v[150:151]
    v_cvt_pk_bf16_f32 v160, v148, v136
    ds_read_b64_tr_b16 a[26:27], v254 offset:16384
    v_cvt_pk_bf16_f32 v161, v149, v137
    v_cvt_pk_bf16_f32 v162, v150, v138
    v_cvt_pk_bf16_f32 v163, v151, v139
    v_pk_mul_f32 v[140:141], v[116:117], v[80:81]
    buffer_load_dwordx4 v253, s[28:31], s39 offen offset:1024 lds
    v_pk_mul_f32 v[152:153], v[128:129], v[80:81]
    v_pk_mul_f32 v[142:143], v[118:119], v[82:83]
    v_pk_mul_f32 v[154:155], v[130:131], v[82:83]
    v_pk_fma_f32 v[140:141], v[128:129], v[92:93], v[140:141] neg_lo:[1,0,0] neg_hi:[1,0,0]
    ds_read_b64_tr_b16 a[28:29], v254 offset:46960
    v_pk_fma_f32 v[152:153], v[116:117], v[92:93], v[152:153]
    v_pk_fma_f32 v[142:143], v[130:131], v[94:95], v[142:143] neg_lo:[1,0,0] neg_hi:[1,0,0]
    v_pk_fma_f32 v[154:155], v[118:119], v[94:95], v[154:155]
    v_cvt_pk_bf16_f32 v164, v152, v140
    ds_read_b64_tr_b16 a[30:31], v254 offset:47728
    v_cvt_pk_bf16_f32 v165, v153, v141
    v_cvt_pk_bf16_f32 v166, v154, v142
    v_cvt_pk_bf16_f32 v167, v155, v143
    v_pk_mul_f32 v[144:145], v[120:121], v[84:85]
    s_add_u32 s39, s39, 30720
    s_add_u32 m0, s55, 7808
    s_nop 0
    buffer_load_dwordx4 v252, s[28:31], s39 offen lds
    v_pk_mul_f32 v[156:157], v[132:133], v[84:85]
    v_pk_mul_f32 v[146:147], v[122:123], v[86:87]
    v_pk_mul_f32 v[158:159], v[134:135], v[86:87]
    v_pk_fma_f32 v[144:145], v[132:133], v[96:97], v[144:145] neg_lo:[1,0,0] neg_hi:[1,0,0]
    ds_read_b64_tr_b16 a[32:33], v205 offset:15616
    v_pk_fma_f32 v[156:157], v[120:121], v[96:97], v[156:157]
    v_pk_fma_f32 v[146:147], v[134:135], v[98:99], v[146:147] neg_lo:[1,0,0] neg_hi:[1,0,0]
    v_pk_fma_f32 v[158:159], v[122:123], v[98:99], v[158:159]
    v_cvt_pk_bf16_f32 v168, v156, v144
    ds_read_b64_tr_b16 a[34:35], v205 offset:16384
    v_cvt_pk_bf16_f32 v169, v157, v145
    v_cvt_pk_bf16_f32 v170, v158, v146
    v_cvt_pk_bf16_f32 v171, v159, v147
    v_mfma_f32_16x16x32_bf16 v[124:127], v[160:163], v[60:63], 0
    buffer_load_dwordx4 v253, s[28:31], s39 offen offset:1024 lds
    v_mfma_f32_16x16x32_bf16 v[112:115], v[160:163], v[64:67], 0
    v_mfma_f32_16x16x32_bf16 v[128:131], v[164:167], v[60:63], 0
    ds_read_b64_tr_b16 a[36:37], v254 offset:23424
    v_mfma_f32_16x16x32_bf16 v[116:119], v[164:167], v[64:67], 0
    v_mfma_f32_16x16x32_bf16 v[132:135], v[168:171], v[60:63], 0
    ds_read_b64_tr_b16 a[38:39], v254 offset:24192
    v_mfma_f32_16x16x32_bf16 v[120:123], v[168:171], v[64:67], 0
    s_nop 1
    v_pk_mul_f32 v[136:137], v[112:113], v[68:69]
    s_mov_b32 s51, 196608
    buffer_load_dwordx4 a[240:243], v188, s[16:19], s51 offen sc1
    v_pk_mul_f32 v[148:149], v[124:125], v[68:69]
    v_pk_mul_f32 v[138:139], v[114:115], v[70:71]
    v_pk_mul_f32 v[150:151], v[126:127], v[70:71]
    v_pk_fma_f32 v[136:137], v[124:125], v[72:73], v[136:137] neg_lo:[1,0,0] neg_hi:[1,0,0]
    ds_read_b64_tr_b16 a[40:41], v254 offset:54768
    v_pk_fma_f32 v[148:149], v[112:113], v[72:73], v[148:149]
    v_pk_fma_f32 v[138:139], v[126:127], v[74:75], v[138:139] neg_lo:[1,0,0] neg_hi:[1,0,0]
    v_pk_fma_f32 v[150:151], v[114:115], v[74:75], v[150:151]
    v_cvt_pk_bf16_f32 v160, v148, v136
    ds_read_b64_tr_b16 a[42:43], v254 offset:55536
    v_cvt_pk_bf16_f32 v161, v149, v137
    v_cvt_pk_bf16_f32 v162, v150, v138
    v_cvt_pk_bf16_f32 v163, v151, v139
    v_pk_mul_f32 v[140:141], v[116:117], v[68:69]
    buffer_load_dwordx4 v[172:175], v189, s[16:19], s51 offen sc1
    v_pk_mul_f32 v[152:153], v[128:129], v[68:69]
    v_pk_mul_f32 v[142:143], v[118:119], v[70:71]
    v_pk_mul_f32 v[154:155], v[130:131], v[70:71]
    v_pk_fma_f32 v[140:141], v[128:129], v[72:73], v[140:141] neg_lo:[1,0,0] neg_hi:[1,0,0]
    ds_read_b64_tr_b16 a[44:45], v205 offset:23424
    v_pk_fma_f32 v[152:153], v[116:117], v[72:73], v[152:153]
    v_pk_fma_f32 v[142:143], v[130:131], v[74:75], v[142:143] neg_lo:[1,0,0] neg_hi:[1,0,0]
    v_pk_fma_f32 v[154:155], v[118:119], v[74:75], v[154:155]
    v_cvt_pk_bf16_f32 v164, v152, v140
    ds_read_b64_tr_b16 a[46:47], v205 offset:24192
    v_cvt_pk_bf16_f32 v165, v153, v141
    v_cvt_pk_bf16_f32 v166, v154, v142
    v_cvt_pk_bf16_f32 v167, v155, v143
    v_pk_mul_f32 v[144:145], v[120:121], v[68:69]
    buffer_load_dwordx2 v[212:213], v232, s[16:19], s51 offen sc1
    v_pk_mul_f32 v[156:157], v[132:133], v[68:69]
    v_pk_mul_f32 v[146:147], v[122:123], v[70:71]
    v_pk_mul_f32 v[158:159], v[134:135], v[70:71]
    v_pk_fma_f32 v[144:145], v[132:133], v[72:73], v[144:145] neg_lo:[1,0,0] neg_hi:[1,0,0]
    ds_read_b64_tr_b16 a[192:193], v211 offset:0
    v_pk_fma_f32 v[156:157], v[120:121], v[72:73], v[156:157]
    v_pk_fma_f32 v[146:147], v[134:135], v[74:75], v[146:147] neg_lo:[1,0,0] neg_hi:[1,0,0]
    v_pk_fma_f32 v[158:159], v[122:123], v[74:75], v[158:159]
    v_cvt_pk_bf16_f32 v168, v156, v144
    ds_read_b64_tr_b16 a[196:197], v211 offset:31344
    v_cvt_pk_bf16_f32 v169, v157, v145
    v_cvt_pk_bf16_f32 v170, v158, v146
    v_cvt_pk_bf16_f32 v171, v159, v147
    v_mfma_f32_16x16x32_bf16 v[124:127], v[60:63], v[160:163], 0
    s_mov_b32 s51, 206848
    buffer_load_dwordx4 a[244:247], v188, s[16:19], s51 offen sc1
    v_mfma_f32_16x16x32_bf16 v[112:115], v[64:67], v[160:163], 0
    v_mfma_f32_16x16x32_bf16 v[128:131], v[60:63], v[164:167], 0
    ds_read_b64_tr_b16 a[200:201], v222 offset:0
    v_mfma_f32_16x16x32_bf16 v[116:119], v[64:67], v[164:167], 0
    v_mfma_f32_16x16x32_bf16 v[132:135], v[60:63], v[168:171], 0
    ds_read_b64_tr_b16 a[204:205], v211 offset:15616
    v_mfma_f32_16x16x32_bf16 v[120:123], v[64:67], v[168:171], 0
    buffer_load_dwordx4 v[176:179], v189, s[16:19], s51 offen sc1
    ds_read_b64_tr_b16 a[208:209], v211 offset:46960
    ds_read_b64_tr_b16 a[212:213], v222 offset:15616
    buffer_load_dwordx2 v[214:215], v232, s[16:19], s51 offen sc1
    s_mov_b32 s51, 217088
    buffer_load_dwordx4 a[248:251], v188, s[16:19], s51 offen sc1
    buffer_load_dwordx4 v[180:183], v189, s[16:19], s51 offen sc1
    buffer_load_dwordx2 v[216:217], v232, s[16:19], s51 offen sc1
    s_mov_b32 s51, 227328
    buffer_load_dwordx4 a[252:255], v188, s[16:19], s51 offen sc1
    buffer_load_dwordx4 v[184:187], v189, s[16:19], s51 offen sc1
    buffer_load_dwordx2 v[218:219], v232, s[16:19], s51 offen sc1
    v_cvt_pk_bf16_f32 v100, v112, v124
    v_cvt_pk_bf16_f32 v101, v113, v125
    v_cvt_pk_bf16_f32 v102, v114, v126
    v_cvt_pk_bf16_f32 v103, v115, v127
    ds_write_b128 v58, v[100:103] offset:0
    v_cvt_pk_bf16_f32 v104, v116, v128
    v_cvt_pk_bf16_f32 v105, v117, v129
    v_cvt_pk_bf16_f32 v106, v118, v130
    v_cvt_pk_bf16_f32 v107, v119, v131
    ds_write_b128 v58, v[104:107] offset:4144
    v_cvt_pk_bf16_f32 v108, v120, v132
    v_cvt_pk_bf16_f32 v109, v121, v133
    v_cvt_pk_bf16_f32 v110, v122, v134
    v_cvt_pk_bf16_f32 v111, v123, v135
    ds_write_b128 v58, v[108:111] offset:8288
    s_waitcnt lgkmcnt(0)
    s_barrier
    ds_read_b32 v40, v55 offset:0
    ds_read_b32 v41, v55 offset:1024
    ds_read_b32 v42, v55 offset:2048
    ds_read_b32 v43, v55 offset:3072
    ds_read_b32 v44, v56 offset:0
    ds_read_b32 v45, v56 offset:1024
    ds_read_b32 v46, v56 offset:2048
    ds_read_b32 v47, v56 offset:3072
    ds_read_b32 v48, v57 offset:0
    ds_read_b32 v49, v57 offset:1024
    ds_read_b32 v50, v57 offset:2048
    ds_read_b32 v51, v57 offset:3072
    s_waitcnt lgkmcnt(8)
    buffer_store_dwordx4 v[40:43], v234, s[16:19], s62 offen offset:0 sc1
    s_waitcnt lgkmcnt(4)
    buffer_store_dwordx4 v[44:47], v234, s[16:19], s62 offen offset:1024 sc1
    s_waitcnt lgkmcnt(0)
    buffer_store_dwordx4 v[48:51], v234, s[16:19], s62 offen offset:2048 sc1
    buffer_load_dwordx4 v[200:203], v6, s[20:23], s36 offen
    buffer_load_dword v204, v6, s[20:23], s36 offen offset:16
    buffer_load_dwordx4 v[206:209], v6, s[20:23], s37 offen
    buffer_load_dword v210, v6, s[20:23], s37 offen offset:16
    s_mov_b32 s32, 327680
    buffer_load_dwordx2 v[152:153], v5, s[16:19], s32 offen sc1
    s_mul_i32 s35, s3, 3584
    s_add_u32 s35, s35, 125440
    v_mul_u32_u24 v244, 112, v3
    v_lshlrev_b32 v245, 3, v4
    v_sub_u32 v245, 88, v245
    v_cmp_eq_u32 vcc, 32, v1
    v_mov_b32 v246, 96
    s_nop 0
    v_cndmask_b32 v245, v245, v246, vcc
    v_add3_u32 v245, v245, v244, s35
    v_mov_b32 v246, 0
    v_mov_b32 v247, 0
    ds_write_b64 v245, v[246:247]
    v_lshl_add_u32 v58, v4, 4, v244
    s_add_u32 s39, s39, 30720
    s_add_u32 m0, s55, 9760
    s_nop 0
    buffer_load_dwordx4 v252, s[28:31], s39 offen lds
    v_add_u32 v58, s35, v58
    v_add_u32 v59, 125536, v244
    s_lshl_b32 s35, s3, 5
    v_cmp_eq_u32 vcc, 0, v4
    v_add_u32 v246, s35, v3
    v_lshl_add_u32 v249, v246, 1, v4
    v_mul_u32_u24 v250, 43691, v249
    v_lshrrev_b32 v250, 17, v250
    v_mul_u32_u24 v52, 12240, v250
    v_lshl_add_u32 v52, v249, 4, v52
    v_sub_u32 v247, 640, v246
    v_cndmask_b32 v247, v247, v246, vcc
    v_and_b32 v248, 31, v247
    v_mul_u32_u24 v248, 112, v248
    v_lshrrev_b32 v247, 5, v247
    v_lshl_add_u32 v55, v247, 2, v248
    buffer_load_dwordx4 v253, s[28:31], s39 offen offset:1024 lds
    v_add_u32 v55, 125440, v55
    v_add_u32 v246, s35, v3
    v_add_u32 v246, 128, v246
    v_lshl_add_u32 v249, v246, 1, v4
    v_mul_u32_u24 v250, 43691, v249
    v_lshrrev_b32 v250, 17, v250
    v_mul_u32_u24 v53, 12240, v250
    v_lshl_add_u32 v53, v249, 4, v53
    v_sub_u32 v247, 640, v246
    v_cndmask_b32 v247, v247, v246, vcc
    v_and_b32 v248, 31, v247
    v_mul_u32_u24 v248, 112, v248
    v_lshrrev_b32 v247, 5, v247
    v_lshl_add_u32 v56, v247, 2, v248
    v_add_u32 v56, 125440, v56
    v_add_u32 v246, s35, v3
    s_add_u32 s39, s39, 30720
    s_add_u32 m0, s55, 11712
    s_nop 0
    buffer_load_dwordx4 v252, s[28:31], s39 offen lds
    v_add_u32 v246, 256, v246
    v_lshl_add_u32 v249, v246, 1, v4
    v_mul_u32_u24 v250, 43691, v249
    v_lshrrev_b32 v250, 17, v250
    v_mul_u32_u24 v54, 12240, v250
    v_lshl_add_u32 v54, v249, 4, v54
    v_sub_u32 v247, 640, v246
    v_cndmask_b32 v247, v247, v246, vcc
    v_and_b32 v248, 31, v247
    v_mul_u32_u24 v248, 112, v248
    v_lshrrev_b32 v247, 5, v247
    v_lshl_add_u32 v57, v247, 2, v248
    v_add_u32 v57, 125440, v57
    v_mov_b32 v248, 641
    v_cmp_eq_u32 s[46:47], v248, v249
    v_mov_b32 v247, 125524
    buffer_load_dwordx4 v253, s[28:31], s39 offen offset:1024 lds
    v_cndmask_b32 v57, v57, v247, s[46:47]
    v_cmp_lt_u32 s[46:47], v248, v249
    v_mov_b32 v247, 1073741824
    s_nop 0
    v_cndmask_b32 v57, v57, v59, s[46:47]
    v_cndmask_b32 v54, v54, v247, s[46:47]
    s_and_b32 s45, s12, 0xc0
    s_and_b32 s35, s12, 15
    s_lshl_b32 s35, s35, 2
    s_add_u32 s45, s45, s35
    s_bfe_u32 s35, s12, 0x20004
    s_add_u32 s45, s45, s35
    s_mul_i32 s45, s45, 48
    s_add_u32 s45, s45, 4194304
    v_accvgpr_read_b32 v84, a96
    v_accvgpr_read_b32 v85, a97
    v_accvgpr_read_b32 v86, a98
    s_add_u32 s39, s39, 30720
    s_add_u32 m0, s55, 13664
    s_nop 0
    buffer_load_dwordx4 v252, s[28:31], s39 offen lds
    v_accvgpr_read_b32 v87, a99
    v_accvgpr_read_b32 v88, a100
    v_accvgpr_read_b32 v89, a101
    v_accvgpr_read_b32 v90, a102
    v_accvgpr_read_b32 v91, a103
    v_accvgpr_read_b32 v92, a104
    v_accvgpr_read_b32 v93, a105
    v_accvgpr_read_b32 v94, a106
    v_accvgpr_read_b32 v95, a107
    v_accvgpr_read_b32 v96, a108
    v_accvgpr_read_b32 v97, a109
    v_accvgpr_read_b32 v98, a110
    v_accvgpr_read_b32 v99, a111
    v_accvgpr_read_b32 v100, a112
    v_accvgpr_read_b32 v101, a113
    v_accvgpr_read_b32 v102, a114
    buffer_load_dwordx4 v253, s[28:31], s39 offen offset:1024 lds
    v_accvgpr_read_b32 v103, a115
    v_accvgpr_read_b32 v104, a116
    v_accvgpr_read_b32 v105, a117
    v_accvgpr_read_b32 v106, a118
    v_accvgpr_read_b32 v107, a119
    v_accvgpr_read_b32 v108, a120
    v_accvgpr_read_b32 v109, a121
    v_accvgpr_read_b32 v110, a122
    v_accvgpr_read_b32 v111, a123
    v_accvgpr_read_b32 v112, a124
    v_accvgpr_read_b32 v113, a125
    v_accvgpr_read_b32 v114, a126
    v_accvgpr_read_b32 v115, a127
    s_waitcnt vmcnt(14)
    v_accvgpr_read_b32 v120, a240
    v_accvgpr_read_b32 v121, a241
    v_accvgpr_read_b32 v122, a242
    s_add_u32 s39, s39, 276480
    s_add_u32 m0, s55, 62688
    s_nop 0
    buffer_load_dwordx4 v252, s[28:31], s39 offen lds
    v_accvgpr_read_b32 v123, a243
    v_accvgpr_read_b32 v124, a244
    v_accvgpr_read_b32 v125, a245
    v_accvgpr_read_b32 v126, a246
    v_accvgpr_read_b32 v127, a247
    v_accvgpr_read_b32 v128, a248
    v_accvgpr_read_b32 v129, a249
    v_accvgpr_read_b32 v130, a250
    v_accvgpr_read_b32 v131, a251
    v_accvgpr_read_b32 v132, a252
    v_accvgpr_read_b32 v133, a253
    v_accvgpr_read_b32 v134, a254
    v_accvgpr_read_b32 v135, a255
    v_pk_add_f32 v[120:121], v[120:121], v[124:125]
    v_pk_add_f32 v[128:129], v[128:129], v[132:133]
    v_pk_add_f32 v[122:123], v[122:123], v[126:127]
    buffer_load_dwordx4 v253, s[28:31], s39 offen offset:1024 lds
    v_pk_add_f32 v[130:131], v[130:131], v[134:135]
    v_pk_add_f32 v[120:121], v[120:121], v[128:129]
    v_pk_add_f32 v[122:123], v[122:123], v[130:131]
    v_pk_add_f32 v[172:173], v[172:173], v[176:177]
    v_pk_add_f32 v[180:181], v[180:181], v[184:185]
    v_pk_add_f32 v[174:175], v[174:175], v[178:179]
    v_pk_add_f32 v[182:183], v[182:183], v[186:187]
    v_pk_add_f32 v[172:173], v[172:173], v[180:181]
    v_pk_add_f32 v[174:175], v[174:175], v[182:183]
    v_pk_add_f32 v[212:213], v[212:213], v[214:215]
    v_pk_add_f32 v[216:217], v[216:217], v[218:219]
    v_pk_add_f32 v[212:213], v[212:213], v[216:217]
    v_cvt_pk_bf16_f32 v120, v120, v121
    v_and_b32 v121, s13, v120
    v_lshlrev_b32 v120, 16, v120
    v_cvt_pk_bf16_f32 v122, v122, v123
    s_add_u32 s39, s39, 30720
    s_add_u32 m0, s55, 64640
    s_nop 0
    buffer_load_dwordx4 v252, s[28:31], s39 offen lds
    v_and_b32 v123, s13, v122
    v_lshlrev_b32 v122, 16, v122
    v_cvt_pk_bf16_f32 v172, v172, v173
    v_and_b32 v173, s13, v172
    v_lshlrev_b32 v172, 16, v172
    v_cvt_pk_bf16_f32 v174, v174, v175
    v_and_b32 v175, s13, v174
    v_lshlrev_b32 v174, 16, v174
    v_cvt_pk_bf16_f32 v212, v212, v213
    v_and_b32 v213, s13, v212
    v_lshlrev_b32 v212, 16, v212
    v_add_u32 v124, -64, v0
    v_cmp_gt_u32 vcc, 0xa0, v124
    s_nop 1
    v_cndmask_b32 v124, 0, 1.0, vcc
    v_add_f32 v172, v124, v172
    v_add_f32 v173, v124, v173
    buffer_load_dwordx4 v253, s[28:31], s39 offen offset:1024 lds
    v_add_f32 v174, v124, v174
    v_add_f32 v175, v124, v175
    v_cvt_pk_bf16_f32 v172, v172, v173
    v_and_b32 v173, s13, v172
    v_lshlrev_b32 v172, 16, v172
    v_cvt_pk_bf16_f32 v174, v174, v175
    v_and_b32 v175, s13, v174
    v_lshlrev_b32 v174, 16, v174
    v_add_u32 v188, 153600, v188
    v_add_u32 v232, 153600, v232
    ds_write_b128 v188, v[120:123]
    ds_write_b128 v188, v[172:175] offset:4096
    ds_write_b64 v232, v[212:213]
    v_and_b32 v236, 15, v1
    v_lshlrev_b32 v236, 4, v236
    v_bfe_u32 v237, v1, 4, 1
    s_add_u32 s39, s39, 30720
    s_add_u32 m0, s55, 66592
    s_nop 0
    buffer_load_dwordx4 v252, s[28:31], s39 offen lds
    v_mul_u32_u24 v234, 49152, v237
    v_lshl_add_u32 v234, v4, 8, v234
    v_add_u32 v234, v234, v236
    v_mul_u32_u24 v235, 49152, v4
    v_lshl_add_u32 v235, v237, 3, v235
    v_add_u32 v235, v235, v236
    s_lshl_b32 s35, s11, 2
    s_add_u32 s35, s35, s3
    s_mul_i32 s56, s35, 768
    s_mul_i32 s35, s10, 393216
    s_add_u32 s56, s56, s35
    s_add_u32 s56, s56, 16777216
    s_add_u32 s57, s56, 98304
    s_add_u32 s58, s56, 196608
    s_add_u32 s59, s56, 294912
    v_mov_b32 v196, -1
    buffer_load_dwordx4 v253, s[28:31], s39 offen offset:1024 lds
    v_mov_b32 v197, -1
    v_mov_b32 v198, -1
    v_mov_b32 v199, -1
    s_waitcnt vmcnt(17)
    buffer_load_dwordx4 v[172:175], v52, s[16:19], s45 offen sc1
    buffer_load_dwordx4 v[176:179], v53, s[16:19], s45 offen sc1
    buffer_load_dwordx4 v[180:183], v54, s[16:19], s45 offen sc1
    s_mov_b32 s34, 16384
    s_waitcnt vmcnt(15)
Ltkc:
    v_xor_b32 v152, s8, v152
    v_xor_b32 v153, s9, v153
    v_or_b32 v152, v152, v153
    v_cmp_ne_u32 vcc, 0, v152
    s_nop 0
    s_cmp_eq_u64 vcc, 0
    s_cbranch_scc1 Ltkc_x
    s_mov_b32 s32, 327680
    buffer_load_dwordx2 v[152:153], v5, s[16:19], s32 offen sc1
    s_waitcnt vmcnt(0)
    s_sub_u32 s34, s34, 1
    s_cbranch_scc0 Ltkc
Ltkc_x:
    s_waitcnt vmcnt(9) lgkmcnt(0)
    s_barrier
    s_add_u32 s39, s39, 30720
    s_add_u32 m0, s55, 68544
    s_nop 0
    buffer_load_dwordx4 v252, s[28:31], s39 offen lds
    v_add_u32 v254, -62688, v254
    v_add_u32 v205, -62688, v205
    v_add_u32 v211, -62688, v211
    v_add_u32 v222, -62688, v222
    ds_read_b64_tr_b16 a[48:49], v254 offset:0
    ds_read_b64_tr_b16 a[50:51], v254 offset:768
    buffer_load_dwordx4 v253, s[28:31], s39 offen offset:1024 lds
    ds_read_b64_tr_b16 a[52:53], v254 offset:31344
    ds_read_b64_tr_b16 a[54:55], v254 offset:32112
    ds_read_b64_tr_b16 a[56:57], v205 offset:0
    s_add_u32 s39, s39, 30720
    s_add_u32 m0, s55, 70496
    s_nop 0
    buffer_load_dwordx4 v252, s[28:31], s39 offen lds
    ds_read_b64_tr_b16 a[58:59], v205 offset:768
    ds_read_b64_tr_b16 a[60:61], v254 offset:7808
    ds_read_b64_tr_b16 a[62:63], v254 offset:8576
    buffer_load_dwordx4 v253, s[28:31], s39 offen offset:1024 lds
    ds_read_b64_tr_b16 a[64:65], v254 offset:39152
    ds_read_b64_tr_b16 a[66:67], v254 offset:39920
    ds_read_b64_tr_b16 a[68:69], v205 offset:7808
    s_add_u32 s39, s39, 30720
    s_add_u32 m0, s55, 72448
    s_nop 0
    buffer_load_dwordx4 v252, s[28:31], s39 offen lds
    ds_read_b64_tr_b16 a[70:71], v205 offset:8576
    ds_read_b64_tr_b16 a[72:73], v254 offset:15616
    ds_read_b64_tr_b16 a[74:75], v254 offset:16384
    buffer_load_dwordx4 v253, s[28:31], s39 offen offset:1024 lds
    ds_read_b64_tr_b16 a[76:77], v254 offset:46960
    ds_read_b64_tr_b16 a[78:79], v254 offset:47728
    ds_read_b64_tr_b16 a[80:81], v205 offset:15616
    s_add_u32 s39, s39, 30720
    s_add_u32 m0, s55, 74400
    s_nop 0
    buffer_load_dwordx4 v252, s[28:31], s39 offen lds
    ds_read_b64_tr_b16 a[82:83], v205 offset:16384
    ds_read_b64_tr_b16 a[84:85], v254 offset:23424
    ds_read_b64_tr_b16 a[86:87], v254 offset:24192
    buffer_load_dwordx4 v253, s[28:31], s39 offen offset:1024 lds
    ds_read_b64_tr_b16 a[88:89], v254 offset:54768
    ds_read_b64_tr_b16 a[90:91], v254 offset:55536
    ds_read_b64_tr_b16 a[92:93], v205 offset:23424
    s_add_u32 s39, s39, 30720
    s_add_u32 m0, s55, 76352
    s_nop 0
    buffer_load_dwordx4 v252, s[28:31], s39 offen lds
    ds_read_b64_tr_b16 a[94:95], v205 offset:24192
    ds_read_b64_tr_b16 a[216:217], v211 offset:0
    ds_read_b64_tr_b16 a[220:221], v211 offset:31344
    buffer_load_dwordx4 v253, s[28:31], s39 offen offset:1024 lds
    ds_read_b64_tr_b16 a[224:225], v222 offset:0
    ds_read_b64_tr_b16 a[228:229], v211 offset:15616
    ds_read_b64_tr_b16 a[232:233], v211 offset:46960
    ds_read_b64_tr_b16 a[236:237], v222 offset:15616
    s_lshr_b32 s14, s12, 3
    s_and_b32 s15, s12, 7
    s_lshl_b32 s35, s15, 2
    s_add_u32 s35, s35, s3
    s_mul_i32 s35, s35, 61440
    s_add_u32 s35, s35, 23068672
    s_add_u32 s20, s4, s35
    s_addc_u32 s21, s5, 0
    s_mov_b32 s22, 61440
    s_and_b32 s53, s2, 1
    s_mul_i32 s53, s53, 983040
    s_mul_i32 s35, s61, 30720
    s_add_u32 s53, s53, s35
    s_add_u32 s53, s53, 23068672
    v_lshlrev_b32 v242, 7, v0
    v_add_u32 v241, 153600, v7
    s_add_u32 s41, s40, 5120
    s_add_u32 s50, s40, 3145728
    s_add_u32 s51, s50, 5120
    ds_read_b64 v[40:41], v241 offset:0
    ds_read_b64 v[42:43], v241 offset:8
    ds_read_b64 v[44:45], v241 offset:16
    ds_read_b64 v[46:47], v241 offset:24
    ds_read_b64 v[48:49], v241 offset:32
    ds_read_b64 v[224:225], v241 offset:2560
    ds_read_b64 v[226:227], v241 offset:2568
    ds_read_b64 v[228:229], v241 offset:2576
    ds_read_b64 v[230:231], v241 offset:2584
    ds_read_b64 v[232:233], v241 offset:2592
    ds_read_b64 v[212:213], v241 offset:5120
    ds_read_b64 v[214:215], v241 offset:5128
    ds_read_b64 v[216:217], v241 offset:5136
    ds_read_b64 v[218:219], v241 offset:5144
    ds_read_b64 v[220:221], v241 offset:5152
    s_waitcnt lgkmcnt(10)
    v_mul_f32 v40, 0x354ccccd, v40
    v_mul_f32 v41, 0x354ccccd, v41
    v_mul_f32 v42, 0x354ccccd, v42
    v_mul_f32 v43, 0x354ccccd, v43
    v_mul_f32 v44, 0x354ccccd, v44
    v_mul_f32 v45, 0x354ccccd, v45
    v_mul_f32 v46, 0x354ccccd, v46
    v_mul_f32 v47, 0x354ccccd, v47
    v_mul_f32 v48, 0x354ccccd, v48
    v_mul_f32 v49, 0x354ccccd, v49
    s_mov_b32 s34, 16384
    s_waitcnt vmcnt(10)
Lp2:
    v_max3_u32 v247, v172, v173, v174
    v_max3_u32 v247, v247, v175, v176
    v_max3_u32 v247, v247, v177, v178
    v_max3_u32 v247, v247, v179, v180
    v_max3_u32 v247, v247, v181, v182
    v_max_u32 v247, v247, v183
    v_cmp_eq_u32 vcc, -1, v247
    s_nop 0
    s_cmp_eq_u64 vcc, 0
    s_cbranch_scc1 Lp2_x
    buffer_load_dwordx4 v[172:175], v52, s[16:19], s45 offen sc1
    buffer_load_dwordx4 v[176:179], v53, s[16:19], s45 offen sc1
    buffer_load_dwordx4 v[180:183], v54, s[16:19], s45 offen sc1
    s_waitcnt vmcnt(0)
    s_sub_u32 s34, s34, 1
    s_cbranch_scc0 Lp2
Lp2_x:
    buffer_load_dword v255, v242, s[16:19], s53 offen sc1
    v_mfma_f32_32x32x16_bf16 v[120:135], a[168:171], v[172:175], 0
    v_mfma_f32_32x32x16_bf16 v[136:151], a[168:171], v[176:179], 0
    v_mfma_f32_32x32x16_bf16 v[152:167], a[168:171], v[180:183], 0
    s_nop 9
    v_cvt_pk_bf16_f32 v184, v120, v121
    ds_write_b32 v55, v184 offset:0
    v_cvt_pk_bf16_f32 v185, v122, v123
    ds_write_b32 v55, v185 offset:3584
    v_cvt_pk_bf16_f32 v186, v124, v125
    ds_write_b32 v55, v186 offset:7168
    v_cvt_pk_bf16_f32 v187, v126, v127
    ds_write_b32 v55, v187 offset:10752
    v_cvt_pk_bf16_f32 v188, v136, v137
    ds_write_b32 v56, v188 offset:0
    v_cvt_pk_bf16_f32 v189, v138, v139
    ds_write_b32 v56, v189 offset:3584
    v_cvt_pk_bf16_f32 v190, v140, v141
    ds_write_b32 v56, v190 offset:7168
    v_cvt_pk_bf16_f32 v191, v142, v143
    ds_write_b32 v56, v191 offset:10752
    v_cvt_pk_bf16_f32 v192, v152, v153
    ds_write_b32 v57, v192 offset:0
    v_cvt_pk_bf16_f32 v193, v154, v155
    ds_write_b32 v57, v193 offset:3584
    v_cvt_pk_bf16_f32 v194, v156, v157
    ds_write_b32 v57, v194 offset:7168
    v_cvt_pk_bf16_f32 v195, v158, v159
    ds_write_b32 v57, v195 offset:10752
    s_waitcnt vmcnt(1) lgkmcnt(0)
    s_barrier
    ds_read_b128 v[172:175], v58 offset:0
    ds_read_b128 v[176:179], v58 offset:32
    ds_read_b128 v[180:183], v58 offset:64
    s_waitcnt lgkmcnt(2)
    v_mfma_f32_32x32x16_bf16 v[120:135], v[172:175], a[144:147], 0
    v_mfma_f32_32x32x16_bf16 v[136:151], v[172:175], a[156:159], 0
    s_waitcnt lgkmcnt(1)
    v_mfma_f32_32x32x16_bf16 v[120:135], v[176:179], a[148:151], v[120:135]
    v_mfma_f32_32x32x16_bf16 v[136:151], v[176:179], a[160:163], v[136:151]
    s_waitcnt lgkmcnt(0)
    v_mfma_f32_32x32x16_bf16 v[120:135], v[180:183], a[152:155], v[120:135]
    v_mfma_f32_32x32x16_bf16 v[136:151], v[180:183], a[164:167], v[136:151]
    s_nop 10
    v_pk_mul_f32 v[152:153], v[120:121], v[84:85]
    v_pk_mul_f32 v[60:61], v[120:121], v[100:101]
    v_pk_mul_f32 v[154:155], v[122:123], v[86:87]
    v_pk_mul_f32 v[62:63], v[122:123], v[102:103]
    v_pk_mul_f32 v[156:157], v[124:125], v[88:89]
    v_pk_mul_f32 v[64:65], v[124:125], v[104:105]
    v_pk_mul_f32 v[158:159], v[126:127], v[90:91]
    v_pk_mul_f32 v[66:67], v[126:127], v[106:107]
    s_add_u32 s39, s39, 276480
    s_add_u32 m0, s55, 0
    s_nop 0
    buffer_load_dwordx4 v252, s[28:31], s39 offen lds
    v_pk_mul_f32 v[160:161], v[128:129], v[92:93]
    v_pk_mul_f32 v[68:69], v[128:129], v[108:109]
    v_pk_mul_f32 v[162:163], v[130:131], v[94:95]
    v_pk_mul_f32 v[70:71], v[130:131], v[110:111]
    v_pk_mul_f32 v[164:165], v[132:133], v[96:97]
    v_pk_mul_f32 v[72:73], v[132:133], v[112:113]
    v_pk_mul_f32 v[166:167], v[134:135], v[98:99]
    v_pk_mul_f32 v[74:75], v[134:135], v[114:115]
    v_add_u32 v254, 62688, v254
    v_add_u32 v205, 62688, v205
    v_add_u32 v211, 62688, v211
    v_add_u32 v222, 62688, v222
    v_pk_fma_f32 v[152:153], v[136:137], v[100:101], v[152:153] neg_lo:[1,0,0] neg_hi:[1,0,0]
    v_pk_fma_f32 v[60:61], v[136:137], v[84:85], v[60:61]
    v_cvt_pk_bf16_f32 v184, v60, v152
    v_cvt_pk_bf16_f32 v185, v61, v153
    v_pk_fma_f32 v[154:155], v[138:139], v[102:103], v[154:155] neg_lo:[1,0,0] neg_hi:[1,0,0]
    v_pk_fma_f32 v[62:63], v[138:139], v[86:87], v[62:63]
    v_cvt_pk_bf16_f32 v186, v62, v154
    v_cvt_pk_bf16_f32 v187, v63, v155
    ds_read_b64_tr_b16 a[96:97], v254 offset:0
    v_pk_fma_f32 v[156:157], v[140:141], v[104:105], v[156:157] neg_lo:[1,0,0] neg_hi:[1,0,0]
    v_pk_fma_f32 v[64:65], v[140:141], v[88:89], v[64:65]
    v_cvt_pk_bf16_f32 v188, v64, v156
    v_cvt_pk_bf16_f32 v189, v65, v157
    v_pk_fma_f32 v[158:159], v[142:143], v[106:107], v[158:159] neg_lo:[1,0,0] neg_hi:[1,0,0]
    v_pk_fma_f32 v[66:67], v[142:143], v[90:91], v[66:67]
    v_cvt_pk_bf16_f32 v190, v66, v158
    v_cvt_pk_bf16_f32 v191, v67, v159
    buffer_load_dwordx4 v253, s[28:31], s39 offen offset:1024 lds
    v_pk_fma_f32 v[160:161], v[144:145], v[108:109], v[160:161] neg_lo:[1,0,0] neg_hi:[1,0,0]
    v_pk_fma_f32 v[68:69], v[144:145], v[92:93], v[68:69]
    v_cvt_pk_bf16_f32 v192, v68, v160
    v_cvt_pk_bf16_f32 v193, v69, v161
    v_pk_fma_f32 v[162:163], v[146:147], v[110:111], v[162:163] neg_lo:[1,0,0] neg_hi:[1,0,0]
    v_pk_fma_f32 v[70:71], v[146:147], v[94:95], v[70:71]
    v_cvt_pk_bf16_f32 v194, v70, v162
    v_cvt_pk_bf16_f32 v195, v71, v163
    ds_read_b64_tr_b16 a[98:99], v254 offset:768
    v_pk_fma_f32 v[164:165], v[148:149], v[112:113], v[164:165] neg_lo:[1,0,0] neg_hi:[1,0,0]
    v_pk_fma_f32 v[72:73], v[148:149], v[96:97], v[72:73]
    v_cvt_pk_bf16_f32 v196, v72, v164
    v_cvt_pk_bf16_f32 v197, v73, v165
    v_pk_fma_f32 v[166:167], v[150:151], v[114:115], v[166:167] neg_lo:[1,0,0] neg_hi:[1,0,0]
    v_pk_fma_f32 v[74:75], v[150:151], v[98:99], v[74:75]
    v_cvt_pk_bf16_f32 v198, v74, v166
    v_cvt_pk_bf16_f32 v199, v75, v167
    ds_read_b64_tr_b16 a[100:101], v254 offset:31344
    v_mfma_f32_32x32x16_bf16 v[136:151], v[184:187], v[8:11], 0
    v_lshlrev_b32 v152, 16, v200
    v_and_b32 v153, s13, v200
    v_lshlrev_b32 v154, 16, v201
    s_add_u32 s39, s39, 30720
    s_add_u32 m0, s55, 1952
    s_nop 0
    buffer_load_dwordx4 v252, s[28:31], s39 offen lds
    v_mfma_f32_32x32x16_bf16 v[120:135], v[184:187], v[24:27], 0
    v_and_b32 v155, s13, v201
    v_lshlrev_b32 v156, 16, v202
    v_and_b32 v157, s13, v202
    ds_read_b64_tr_b16 a[102:103], v254 offset:32112
    v_mfma_f32_32x32x16_bf16 v[136:151], v[188:191], v[12:15], v[136:151]
    v_lshlrev_b32 v158, 16, v203
    v_and_b32 v159, s13, v203
    v_lshlrev_b32 v160, 16, v204
    ds_read_b64_tr_b16 a[104:105], v205 offset:0
    v_mfma_f32_32x32x16_bf16 v[120:135], v[188:191], v[28:31], v[120:135]
    v_and_b32 v161, s13, v204
    v_lshlrev_b32 v162, 16, v206
    v_and_b32 v163, s13, v206
    buffer_load_dwordx4 v253, s[28:31], s39 offen offset:1024 lds
    v_mfma_f32_32x32x16_bf16 v[136:151], v[192:195], v[16:19], v[136:151]
    v_lshlrev_b32 v164, 16, v207
    v_and_b32 v165, s13, v207
    v_lshlrev_b32 v166, 16, v208
    ds_read_b64_tr_b16 a[106:107], v205 offset:768
    v_mfma_f32_32x32x16_bf16 v[120:135], v[192:195], v[32:35], v[120:135]
    v_and_b32 v167, s13, v208
    v_lshlrev_b32 v168, 16, v209
    v_and_b32 v169, s13, v209
    ds_read_b64_tr_b16 a[108:109], v254 offset:7808
    v_mfma_f32_32x32x16_bf16 v[136:151], v[196:199], v[20:23], v[136:151]
    v_lshlrev_b32 v170, 16, v210
    v_and_b32 v171, s13, v210
    v_mfma_f32_32x32x16_bf16 v[120:135], v[196:199], v[36:39], v[120:135]
    s_add_u32 s39, s39, 30720
    s_add_u32 m0, s55, 3904
    s_nop 0
    buffer_load_dwordx4 v252, s[28:31], s39 offen lds
    s_nop 4
    v_pk_fma_f32 v[162:163], v[136:137], v[40:41], v[162:163]
    v_pk_fma_f32 v[164:165], v[138:139], v[42:43], v[164:165]
    v_pk_fma_f32 v[166:167], v[140:141], v[44:45], v[166:167]
    v_pk_fma_f32 v[168:169], v[142:143], v[46:47], v[168:169]
    v_pk_fma_f32 v[170:171], v[144:145], v[48:49], v[170:171]
    v_pk_fma_f32 v[152:153], v[120:121], v[40:41], v[152:153]
    v_pk_fma_f32 v[154:155], v[122:123], v[42:43], v[154:155]
    v_pk_fma_f32 v[156:157], v[124:125], v[44:45], v[156:157]
    ds_read_b64_tr_b16 a[110:111], v254 offset:8576
    v_pk_fma_f32 v[158:159], v[126:127], v[46:47], v[158:159]
    v_pk_fma_f32 v[160:161], v[128:129], v[48:49], v[160:161]
    v_cvt_pk_bf16_f32 v200, v152, v153
    v_cvt_pk_bf16_f32 v206, v162, v163
    v_cvt_pk_bf16_f32 v201, v154, v155
    v_cvt_pk_bf16_f32 v207, v164, v165
    v_cvt_pk_bf16_f32 v202, v156, v157
    v_cvt_pk_bf16_f32 v208, v166, v167
    ds_read_b64_tr_b16 a[112:113], v254 offset:39152
    v_cvt_pk_bf16_f32 v203, v158, v159
    v_cvt_pk_bf16_f32 v209, v168, v169
    v_cvt_pk_bf16_f32 v204, v160, v161
    v_cvt_pk_bf16_f32 v210, v170, v171
    v_dot2_f32_bf16 v244, v200, s33, 0
    v_dot2_f32_bf16 v245, v206, s33, 0
    v_dot2_f32_bf16 v246, v200, v200, 0
    v_dot2_f32_bf16 v247, v206, v206, 0
    buffer_load_dwordx4 v253, s[28:31], s39 offen offset:1024 lds
    v_dot2_f32_bf16 v244, v201, s33, v244
    v_dot2_f32_bf16 v245, v207, s33, v245
    v_dot2_f32_bf16 v246, v201, v201, v246
    v_dot2_f32_bf16 v247, v207, v207, v247
    v_dot2_f32_bf16 v244, v202, s33, v244
    v_dot2_f32_bf16 v245, v208, s33, v245
    v_dot2_f32_bf16 v246, v202, v202, v246
    v_dot2_f32_bf16 v247, v208, v208, v247
    ds_read_b64_tr_b16 a[114:115], v254 offset:39920
    v_dot2_f32_bf16 v244, v203, s33, v244
    v_dot2_f32_bf16 v245, v209, s33, v245
    v_dot2_f32_bf16 v246, v203, v203, v246
    v_dot2_f32_bf16 v247, v209, v209, v247
    v_dot2_f32_bf16 v244, v204, s33, v244
    v_dot2_f32_bf16 v245, v210, s33, v245
    v_dot2_f32_bf16 v246, v204, v204, v246
    v_dot2_f32_bf16 v247, v210, v210, v247
    ds_read_b64_tr_b16 a[116:117], v205 offset:7808
    v_add_f32_dpp v244, v244, v244 quad_perm:[1,0,3,2] row_mask:0xf bank_mask:0xf
    v_add_f32_dpp v245, v245, v245 quad_perm:[1,0,3,2] row_mask:0xf bank_mask:0xf
    v_add_f32_dpp v246, v246, v246 quad_perm:[1,0,3,2] row_mask:0xf bank_mask:0xf
    v_add_f32_dpp v247, v247, v247 quad_perm:[1,0,3,2] row_mask:0xf bank_mask:0xf
    v_add_f32_dpp v244, v244, v244 quad_perm:[2,3,0,1] row_mask:0xf bank_mask:0xf
    v_add_f32_dpp v245, v245, v245 quad_perm:[2,3,0,1] row_mask:0xf bank_mask:0xf
    v_add_f32_dpp v246, v246, v246 quad_perm:[2,3,0,1] row_mask:0xf bank_mask:0xf
    v_add_f32_dpp v247, v247, v247 quad_perm:[2,3,0,1] row_mask:0xf bank_mask:0xf
    s_add_u32 s39, s39, 30720
    s_add_u32 m0, s55, 5856
    s_nop 0
    buffer_load_dwordx4 v252, s[28:31], s39 offen lds
    v_add_f32_dpp v244, v244, v244 row_ror:4 row_mask:0xf bank_mask:0xf
    v_add_f32_dpp v245, v245, v245 row_ror:4 row_mask:0xf bank_mask:0xf
    v_add_f32_dpp v246, v246, v246 row_ror:4 row_mask:0xf bank_mask:0xf
    v_add_f32_dpp v247, v247, v247 row_ror:4 row_mask:0xf bank_mask:0xf
    v_add_f32_dpp v244, v244, v244 row_ror:8 row_mask:0xf bank_mask:0xf
    v_add_f32_dpp v245, v245, v245 row_ror:8 row_mask:0xf bank_mask:0xf
    v_add_f32_dpp v246, v246, v246 row_ror:8 row_mask:0xf bank_mask:0xf
    v_add_f32_dpp v247, v247, v247 row_ror:8 row_mask:0xf bank_mask:0xf
    ds_read_b64_tr_b16 a[118:119], v205 offset:8576
    v_add_f32_dpp v244, v244, v244 row_bcast:15 row_mask:0xa bank_mask:0xf
    v_add_f32_dpp v245, v245, v245 row_bcast:15 row_mask:0xa bank_mask:0xf
    v_add_f32_dpp v246, v246, v246 row_bcast:15 row_mask:0xa bank_mask:0xf
    v_add_f32_dpp v247, v247, v247 row_bcast:15 row_mask:0xa bank_mask:0xf
    v_add_f32_dpp v244, v244, v244 row_bcast:31 row_mask:0xc bank_mask:0xf
    v_add_f32_dpp v245, v245, v245 row_bcast:31 row_mask:0xc bank_mask:0xf
    v_add_f32_dpp v246, v246, v246 row_bcast:31 row_mask:0xc bank_mask:0xf
    v_add_f32_dpp v247, v247, v247 row_bcast:31 row_mask:0xc bank_mask:0xf
    ds_read_b64_tr_b16 a[120:121], v254 offset:15616
    v_readlane_b32 s44, v244, 63
    v_readlane_b32 s45, v245, 63
    v_readlane_b32 s46, v246, 63
    v_readlane_b32 s47, v247, 63
    v_mov_b32 v248, 0x3acccccd
    v_mov_b32 v249, 0x3727c5ac
    v_pk_mul_f32 v[250:251], v[248:249], s[44:45] op_sel_hi:[0,1]
    v_pk_fma_f32 v[244:245], v[248:249], s[46:47], v[248:249] op_sel:[0,0,1] op_sel_hi:[0,1,1]
    buffer_load_dwordx4 v253, s[28:31], s39 offen offset:1024 lds
    v_pk_fma_f32 v[244:245], v[250:251], v[250:251], v[244:245] neg_lo:[1,0,0] neg_hi:[1,0,0]
    v_max_f32 v244, v249, v244
    v_max_f32 v245, v249, v245
    v_rsq_f32 v244, v244
    v_rsq_f32 v245, v245
    v_lshlrev_b32 v152, 16, v200
    ds_read_b64_tr_b16 a[122:123], v254 offset:16384
    v_and_b32 v153, s13, v200
    v_lshlrev_b32 v154, 16, v201
    v_and_b32 v155, s13, v201
    v_lshlrev_b32 v156, 16, v202
    v_and_b32 v157, s13, v202
    v_lshlrev_b32 v158, 16, v203
    v_and_b32 v159, s13, v203
    v_lshlrev_b32 v160, 16, v204
    ds_read_b64_tr_b16 a[124:125], v254 offset:46960
    v_and_b32 v161, s13, v204
    v_lshlrev_b32 v162, 16, v206
    v_and_b32 v163, s13, v206
    v_lshlrev_b32 v164, 16, v207
    v_and_b32 v165, s13, v207
    v_lshlrev_b32 v166, 16, v208
    v_and_b32 v167, s13, v208
    v_lshlrev_b32 v168, 16, v209
    s_add_u32 s39, s39, 30720
    s_add_u32 m0, s55, 7808
    s_nop 0
    buffer_load_dwordx4 v252, s[28:31], s39 offen lds
    v_and_b32 v169, s13, v209
    v_lshlrev_b32 v170, 16, v210
    v_and_b32 v171, s13, v210
    v_mov_b32 v198, v204
    v_mov_b32 v199, v210
    v_pk_mul_f32 v[246:247], v[250:251], v[244:245] neg_lo:[1,0] neg_hi:[1,0]
    v_pk_fma_f32 v[152:153], v[152:153], v[244:245], v[246:247] op_sel:[0,0,0] op_sel_hi:[1,0,0]
    v_pk_fma_f32 v[154:155], v[154:155], v[244:245], v[246:247] op_sel:[0,0,0] op_sel_hi:[1,0,0]
    v_pk_fma_f32 v[156:157], v[156:157], v[244:245], v[246:247] op_sel:[0,0,0] op_sel_hi:[1,0,0]
    v_pk_fma_f32 v[158:159], v[158:159], v[244:245], v[246:247] op_sel:[0,0,0] op_sel_hi:[1,0,0]
    v_pk_fma_f32 v[160:161], v[160:161], v[244:245], v[246:247] op_sel:[0,0,0] op_sel_hi:[1,0,0]
    v_pk_fma_f32 v[152:153], v[152:153], v[212:213], v[224:225]
    v_pk_fma_f32 v[154:155], v[154:155], v[214:215], v[226:227]
    v_pk_fma_f32 v[156:157], v[156:157], v[216:217], v[228:229]
    v_pk_fma_f32 v[158:159], v[158:159], v[218:219], v[230:231]
    v_pk_fma_f32 v[160:161], v[160:161], v[220:221], v[232:233]
    v_cvt_pk_bf16_f32 v184, v152, v153
    v_cvt_pk_bf16_f32 v185, v154, v155
    v_cvt_pk_bf16_f32 v186, v156, v157
    v_cvt_pk_bf16_f32 v187, v158, v159
    buffer_store_dwordx4 v[184:187], v238, s[16:19], s40 offen sc1
    v_cvt_pk_bf16_f32 v196, v160, v161
    v_pk_fma_f32 v[162:163], v[162:163], v[244:245], v[246:247] op_sel:[0,1,1] op_sel_hi:[1,1,1]
    v_pk_fma_f32 v[164:165], v[164:165], v[244:245], v[246:247] op_sel:[0,1,1] op_sel_hi:[1,1,1]
    v_pk_fma_f32 v[166:167], v[166:167], v[244:245], v[246:247] op_sel:[0,1,1] op_sel_hi:[1,1,1]
    v_pk_fma_f32 v[168:169], v[168:169], v[244:245], v[246:247] op_sel:[0,1,1] op_sel_hi:[1,1,1]
    v_pk_fma_f32 v[170:171], v[170:171], v[244:245], v[246:247] op_sel:[0,1,1] op_sel_hi:[1,1,1]
    v_pk_fma_f32 v[162:163], v[162:163], v[212:213], v[224:225]
    v_pk_fma_f32 v[164:165], v[164:165], v[214:215], v[226:227]
    v_pk_fma_f32 v[166:167], v[166:167], v[216:217], v[228:229]
    v_pk_fma_f32 v[168:169], v[168:169], v[218:219], v[230:231]
    v_pk_fma_f32 v[170:171], v[170:171], v[220:221], v[232:233]
    v_cvt_pk_bf16_f32 v188, v162, v163
    v_cvt_pk_bf16_f32 v189, v164, v165
    v_cvt_pk_bf16_f32 v190, v166, v167
    v_cvt_pk_bf16_f32 v191, v168, v169
    buffer_store_dwordx4 v[188:191], v238, s[16:19], s41 offen sc1
    v_cvt_pk_bf16_f32 v197, v170, v171
    v_permlane16_swap_b32 v196, v198
    s_nop 0
    v_permlane16_swap_b32 v197, v199
    s_nop 1
    v_permlane32_swap_b32 v196, v197
    v_permlane32_swap_b32 v198, v199
    buffer_store_dwordx4 v[196:199], v239, s[16:19], s40 offen offset:1024 sc1
    ds_read_b64_tr_b16 a[126:127], v254 offset:47728
    ds_read_b64_tr_b16 a[128:129], v205 offset:15616
    buffer_load_dwordx4 v253, s[28:31], s39 offen offset:1024 lds
    ds_read_b64_tr_b16 a[130:131], v205 offset:16384
    ds_read_b64_tr_b16 a[132:133], v254 offset:23424
    s_add_u32 s39, s39, 30720
    s_add_u32 m0, s55, 9760
    s_nop 0
    buffer_load_dwordx4 v252, s[28:31], s39 offen lds
    ds_read_b64_tr_b16 a[134:135], v254 offset:24192
    ds_read_b64_tr_b16 a[136:137], v254 offset:54768
    buffer_load_dwordx4 v253, s[28:31], s39 offen offset:1024 lds
    ds_read_b64_tr_b16 a[138:139], v254 offset:55536
    ds_read_b64_tr_b16 a[140:141], v205 offset:23424
    s_add_u32 s39, s39, 30720
    s_add_u32 m0, s55, 11712
    s_nop 0
    buffer_load_dwordx4 v252, s[28:31], s39 offen lds
    ds_read_b64_tr_b16 a[142:143], v205 offset:24192
    ds_read_b64_tr_b16 a[194:195], v211 offset:0
    buffer_load_dwordx4 v253, s[28:31], s39 offen offset:1024 lds
    ds_read_b64_tr_b16 a[198:199], v211 offset:31344
    ds_read_b64_tr_b16 a[202:203], v222 offset:0
    s_add_u32 s39, s39, 30720
    s_add_u32 m0, s55, 13664
    s_nop 0
    buffer_load_dwordx4 v252, s[28:31], s39 offen lds
    ds_read_b64_tr_b16 a[206:207], v211 offset:15616
    ds_read_b64_tr_b16 a[210:211], v211 offset:46960
    buffer_load_dwordx4 v253, s[28:31], s39 offen offset:1024 lds
    ds_read_b64_tr_b16 a[214:215], v222 offset:15616
    s_mul_i32 s54, s3, 15360
    s_mov_b32 s39, 0
    buffer_load_dwordx4 a[240:243], v2, s[20:23], s39 offen offset:0 sc1
    buffer_load_dwordx4 a[244:247], v2, s[20:23], s39 offen offset:1024 sc1
    buffer_load_dwordx4 a[248:251], v2, s[20:23], s39 offen offset:2048 sc1
    buffer_load_dwordx4 a[252:255], v2, s[20:23], s39 offen offset:3072 sc1
    v_lshrrev_b32 v226, 3, v1
    v_and_b32 v227, 7, v1
    v_xor_b32 v228, v226, v227
    v_mul_u32_u24 v232, 1280, v226
    v_lshl_add_u32 v232, v228, 4, v232
    s_lshl_b32 s44, s10, 2
    s_add_u32 s44, s44, s3
    s_mul_i32 s44, s44, 40960
    s_add_u32 s44, s44, 10485760
    s_add_u32 s45, s44, 10240
    s_add_u32 s46, s44, 20480
    s_add_u32 s47, s44, 30720
    v_mov_b32 v240, s8
    v_mov_b32 v241, s9
    v_mov_b32 v242, 0
    s_lshl_b32 s52, s12, 2
    s_add_u32 s52, s52, s3
    s_lshl_b32 s52, s52, 3
    s_add_u32 s52, s52, 65536
    s_lshl_b32 s53, s10, 9
    s_add_u32 s53, s53, 65536
    v_lshlrev_b32 v243, 3, v1
    s_waitcnt vmcnt(11)
    s_mov_b64 exec, 1
    buffer_atomic_swap_x2 v[240:241], v242, s[16:19], s52 offen sc1
    s_mov_b64 exec, -1
    buffer_load_dwordx4 v[168:171], v232, s[16:19], s44 offen offset:0 sc1
    buffer_load_dwordx4 v[172:175], v232, s[16:19], s45 offen offset:0 sc1
    buffer_load_dwordx4 v[176:179], v232, s[16:19], s46 offen offset:0 sc1
    buffer_load_dwordx4 v[180:183], v232, s[16:19], s47 offen offset:0 sc1
    buffer_load_dwordx4 v[8:11], v232, s[16:19], s44 offen offset:128 sc1
    buffer_load_dwordx4 v[12:15], v232, s[16:19], s45 offen offset:128 sc1
    buffer_load_dwordx4 v[16:19], v232, s[16:19], s46 offen offset:128 sc1
    buffer_load_dwordx4 v[20:23], v232, s[16:19], s47 offen offset:128 sc1
    buffer_load_dwordx4 v[24:27], v232, s[16:19], s44 offen offset:256 sc1
    buffer_load_dwordx4 v[28:31], v232, s[16:19], s45 offen offset:256 sc1
    buffer_load_dwordx4 v[32:35], v232, s[16:19], s46 offen offset:256 sc1
    buffer_load_dwordx4 v[36:39], v232, s[16:19], s47 offen offset:256 sc1
    buffer_store_dwordx4 v[200:203], v238, s[16:19], s50 offen sc1
    buffer_store_dwordx4 v[206:209], v238, s[16:19], s51 offen sc1
    s_lshl_b32 s38, s3, 12
    s_add_u32 s38, s38, 62720
    v_add_u32 v236, s54, v2
    v_add_u32 v233, s38, v2
    v_lshrrev_b32 v226, 4, v1
    v_xor_b32 v228, v226, v227
    v_and_b32 v229, 15, v1
    v_lshlrev_b32 v244, 7, v229
    v_lshl_add_u32 v244, v228, 4, v244
    v_add_u32 v244, 62720, v244
    v_xor_b32 v245, 64, v244
    v_add_u32 v246, 0x10000, v244
    v_add_u32 v247, 0x10000, v245
    s_lshr_b32 s35, s14, 1
    s_mul_i32 s48, s35, 393216
    s_and_b32 s42, s14, 1
    s_mul_i32 s42, s42, 49152
    s_add_u32 s48, s48, s42
    s_mul_i32 s42, s3, 12288
    s_add_u32 s48, s48, s42
    s_add_u32 s48, s48, 16777216
    s_add_u32 s49, s48, 4096
    s_add_u32 s50, s48, 8192
    s_lshl_b32 s60, s35, 4
    s_lshl_b32 s42, s3, 2
    s_add_u32 s60, s60, s42
    s_and_b32 s42, s14, 1
    s_lshl_b32 s42, s42, 1
    s_add_u32 s60, s60, s42
    s_mul_i32 s62, s60, 10240
    s_add_u32 s62, s62, 13631488
    s_lshl_b32 s61, s15, 7
    s_add_u32 s61, s61, s62
    s_and_b32 s42, s15, 3
    s_lshl_b32 s42, s42, 6
    s_add_u32 s62, s62, s42
    s_and_b32 s42, s15, 4
    s_lshl_b32 s42, s42, 1
    s_add_u32 s62, s62, s42
    v_add_u32 v226, 98304, v2
    v_add_u32 v227, 196608, v2
    v_add_u32 v228, 294912, v2
    s_waitcnt lgkmcnt(0)
    s_barrier
    s_mov_b32 s34, 16384
    s_waitcnt vmcnt(10)
Lp3:
    v_max3_u32 v250, v168, v169, v170
    v_max3_u32 v250, v250, v171, v172
    v_max3_u32 v250, v250, v173, v174
    v_max3_u32 v250, v250, v175, v176
    v_max3_u32 v250, v250, v177, v178
    v_max3_u32 v250, v250, v179, v180
    v_max3_u32 v250, v250, v181, v182
    v_max_u32 v250, v250, v183
    v_cmp_eq_u32 vcc, -1, v250
    s_nop 0
    s_cmp_eq_u64 vcc, 0
    s_cbranch_scc1 Lp3_x
    buffer_load_dwordx4 v[168:171], v232, s[16:19], s44 offen offset:0 sc1
    buffer_load_dwordx4 v[172:175], v232, s[16:19], s45 offen offset:0 sc1
    buffer_load_dwordx4 v[176:179], v232, s[16:19], s46 offen offset:0 sc1
    buffer_load_dwordx4 v[180:183], v232, s[16:19], s47 offen offset:0 sc1
    buffer_load_dwordx4 v[8:11], v232, s[16:19], s44 offen offset:128 sc1
    buffer_load_dwordx4 v[12:15], v232, s[16:19], s45 offen offset:128 sc1
    buffer_load_dwordx4 v[16:19], v232, s[16:19], s46 offen offset:128 sc1
    buffer_load_dwordx4 v[20:23], v232, s[16:19], s47 offen offset:128 sc1
    buffer_load_dwordx4 v[24:27], v232, s[16:19], s44 offen offset:256 sc1
    buffer_load_dwordx4 v[28:31], v232, s[16:19], s45 offen offset:256 sc1
    buffer_load_dwordx4 v[32:35], v232, s[16:19], s46 offen offset:256 sc1
    buffer_load_dwordx4 v[36:39], v232, s[16:19], s47 offen offset:256 sc1
    s_waitcnt vmcnt(0)
    s_sub_u32 s34, s34, 1
    s_cbranch_scc0 Lp3
Lp3_x:
    ds_write_b128 v233, v[168:171] offset:0
    ds_write_b128 v233, v[172:175] offset:1024
    ds_write_b128 v233, v[176:179] offset:2048
    ds_write_b128 v233, v[180:183] offset:3072
    s_waitcnt lgkmcnt(0)
    s_barrier
    s_add_u32 s41, s52, 16384
    s_add_u32 s63, s53, 16384
    v_mov_b32 v216, -1
    v_mov_b32 v217, -1
    v_mov_b32 v218, -1
    v_mov_b32 v219, -1
    ds_read_b128 v[136:139], v244 offset:0
    ds_read_b128 v[140:143], v244 offset:2048
    ds_read_b128 v[144:147], v244 offset:4096
    ds_read_b128 v[148:151], v244 offset:6144
    ds_read_b128 v[152:155], v244 offset:8192
    ds_read_b128 v[156:159], v244 offset:10240
    ds_read_b128 v[160:163], v244 offset:12288
    ds_read_b128 v[164:167], v244 offset:14336
    s_waitcnt lgkmcnt(7)
    v_mfma_f32_16x16x32_bf16 v[40:43], a[0:3], v[136:139], 0
    ds_read_b128 v[168:171], v245 offset:0
    v_add_u32 v254, -62688, v254
    v_add_u32 v205, -62688, v205
    v_add_u32 v211, -62688, v211
    v_add_u32 v222, -62688, v222
    buffer_store_dwordx4 v[216:219], v234, s[16:19], s56 offen sc1
    v_mfma_f32_16x16x32_bf16 v[44:47], a[4:7], v[136:139], 0
    v_mfma_f32_16x16x32_bf16 v[48:51], a[8:11], v[136:139], 0
    s_waitcnt lgkmcnt(7)
    v_mfma_f32_16x16x32_bf16 v[52:55], a[0:3], v[140:143], 0
    ds_read_b128 v[172:175], v245 offset:2048
    ds_read_b64_tr_b16 a[144:145], v254 offset:0
    v_mfma_f32_16x16x32_bf16 v[56:59], a[4:7], v[140:143], 0
    buffer_store_dwordx2 v[216:217], v235, s[16:19], s56 offen offset:512 sc1
    v_mfma_f32_16x16x32_bf16 v[60:63], a[8:11], v[140:143], 0
    s_waitcnt lgkmcnt(8)
    v_mfma_f32_16x16x32_bf16 v[64:67], a[0:3], v[144:147], 0
    ds_read_b128 v[176:179], v245 offset:4096
    ds_read_b64_tr_b16 a[146:147], v254 offset:768
    v_mfma_f32_16x16x32_bf16 v[68:71], a[4:7], v[144:147], 0
    v_mfma_f32_16x16x32_bf16 v[72:75], a[8:11], v[144:147], 0
    buffer_store_dwordx4 v[216:219], v234, s[16:19], s57 offen sc1
    s_waitcnt lgkmcnt(9)
    v_mfma_f32_16x16x32_bf16 v[76:79], a[0:3], v[148:151], 0
    ds_read_b128 v[180:183], v245 offset:6144
    ds_read_b64_tr_b16 a[148:149], v254 offset:31344
    v_mfma_f32_16x16x32_bf16 v[80:83], a[4:7], v[148:151], 0
    v_mfma_f32_16x16x32_bf16 v[84:87], a[8:11], v[148:151], 0
    buffer_store_dwordx2 v[216:217], v235, s[16:19], s57 offen offset:512 sc1
    s_waitcnt lgkmcnt(10)
    v_mfma_f32_16x16x32_bf16 v[88:91], a[0:3], v[152:155], 0
    ds_read_b128 v[184:187], v245 offset:8192
    ds_read_b64_tr_b16 a[150:151], v254 offset:32112
    v_mfma_f32_16x16x32_bf16 v[92:95], a[4:7], v[152:155], 0
    v_mfma_f32_16x16x32_bf16 v[96:99], a[8:11], v[152:155], 0
    buffer_store_dwordx4 v[216:219], v234, s[16:19], s58 offen sc1
    s_mov_b32 s34, 16384
    s_waitcnt vmcnt(7)
Lp3b:
    v_max3_u32 v250, v8, v9, v10
    v_max3_u32 v250, v250, v11, v12
    v_max3_u32 v250, v250, v13, v14
    v_max3_u32 v250, v250, v15, v16
    v_max3_u32 v250, v250, v17, v18
    v_max3_u32 v250, v250, v19, v20
    v_max3_u32 v250, v250, v21, v22
    v_max3_u32 v250, v250, v23, v24
    v_max3_u32 v250, v250, v25, v26
    v_max3_u32 v250, v250, v27, v28
    v_max3_u32 v250, v250, v29, v30
    v_max3_u32 v250, v250, v31, v32
    v_max3_u32 v250, v250, v33, v34
    v_max3_u32 v250, v250, v35, v36
    v_max3_u32 v250, v250, v37, v38
    v_max_u32 v250, v250, v39
    v_cmp_eq_u32 vcc, -1, v250
    s_nop 0
    s_cmp_eq_u64 vcc, 0
    s_cbranch_scc1 Lp3b_x
    buffer_load_dwordx4 v[8:11], v232, s[16:19], s44 offen offset:128 sc1
    buffer_load_dwordx4 v[12:15], v232, s[16:19], s45 offen offset:128 sc1
    buffer_load_dwordx4 v[16:19], v232, s[16:19], s46 offen offset:128 sc1
    buffer_load_dwordx4 v[20:23], v232, s[16:19], s47 offen offset:128 sc1
    buffer_load_dwordx4 v[24:27], v232, s[16:19], s44 offen offset:256 sc1
    buffer_load_dwordx4 v[28:31], v232, s[16:19], s45 offen offset:256 sc1
    buffer_load_dwordx4 v[32:35], v232, s[16:19], s46 offen offset:256 sc1
    buffer_load_dwordx4 v[36:39], v232, s[16:19], s47 offen offset:256 sc1
    s_waitcnt vmcnt(0)
    s_sub_u32 s34, s34, 1
    s_cbranch_scc0 Lp3b
Lp3b_x:
    v_add_u32 v232, 256, v232
    s_waitcnt lgkmcnt(11)
    v_mfma_f32_16x16x32_bf16 v[100:103], a[0:3], v[156:159], 0
    ds_read_b128 v[188:191], v245 offset:10240
    ds_write_b128 v233, v[8:11] offset:16384
    ds_write_b128 v233, v[12:15] offset:17408
    v_mfma_f32_16x16x32_bf16 v[104:107], a[4:7], v[156:159], 0
    ds_write_b128 v233, v[16:19] offset:18432
    ds_write_b128 v233, v[20:23] offset:19456
    v_mfma_f32_16x16x32_bf16 v[108:111], a[8:11], v[156:159], 0
    ds_read_b64_tr_b16 a[152:153], v205 offset:0
    buffer_store_dwordx2 v[216:217], v235, s[16:19], s58 offen offset:512 sc1
    s_waitcnt lgkmcnt(15)
    v_mfma_f32_16x16x32_bf16 v[112:115], a[0:3], v[160:163], 0
    ds_read_b128 v[192:195], v245 offset:12288
    ds_write_b128 v233, v[24:27] offset:32768
    ds_write_b128 v233, v[28:31] offset:33792
    v_mfma_f32_16x16x32_bf16 v[116:119], a[4:7], v[160:163], 0
    ds_write_b128 v233, v[32:35] offset:34816
    ds_write_b128 v233, v[36:39] offset:35840
    v_mfma_f32_16x16x32_bf16 v[120:123], a[8:11], v[160:163], 0
    buffer_load_dwordx2 v[252:253], v243, s[16:19], s53 offen sc1
    ds_read_b64_tr_b16 a[154:155], v205 offset:768
    buffer_store_dwordx4 v[216:219], v234, s[16:19], s59 offen sc1
    v_mfma_f32_16x16x32_bf16 v[124:127], a[0:3], v[164:167], 0
    ds_read_b128 v[196:199], v245 offset:14336
    ds_read_b64_tr_b16 a[156:157], v254 offset:7808
    v_mfma_f32_16x16x32_bf16 v[128:131], a[4:7], v[164:167], 0
    v_mfma_f32_16x16x32_bf16 v[132:135], a[8:11], v[164:167], 0
    buffer_store_dwordx2 v[216:217], v235, s[16:19], s59 offen offset:512 sc1
    s_waitcnt lgkmcnt(3)
    s_barrier
    v_mfma_f32_16x16x32_bf16 v[40:43], a[12:15], v[168:171], v[40:43]
    ds_read_b128 v[136:139], v244 offset:16384
    ds_read_b64_tr_b16 a[158:159], v254 offset:8576
    v_mfma_f32_16x16x32_bf16 v[44:47], a[16:19], v[168:171], v[44:47]
    v_mfma_f32_16x16x32_bf16 v[48:51], a[20:23], v[168:171], v[48:51]
    v_mfma_f32_16x16x32_bf16 v[52:55], a[12:15], v[172:175], v[52:55]
    ds_read_b128 v[140:143], v244 offset:18432
    ds_read_b64_tr_b16 a[160:161], v254 offset:39152
    s_mov_b32 s39, 4096
    buffer_load_dwordx4 v[8:11], v2, s[20:23], s39 offen offset:0 sc1
    v_mfma_f32_16x16x32_bf16 v[56:59], a[16:19], v[172:175], v[56:59]
    v_mfma_f32_16x16x32_bf16 v[60:63], a[20:23], v[172:175], v[60:63]
    v_mfma_f32_16x16x32_bf16 v[64:67], a[12:15], v[176:179], v[64:67]
    ds_read_b128 v[144:147], v244 offset:20480
    ds_read_b64_tr_b16 a[162:163], v254 offset:39920
    v_mfma_f32_16x16x32_bf16 v[68:71], a[16:19], v[176:179], v[68:71]
    buffer_load_dwordx4 v[12:15], v2, s[20:23], s39 offen offset:1024 sc1
    v_mfma_f32_16x16x32_bf16 v[72:75], a[20:23], v[176:179], v[72:75]
    v_mfma_f32_16x16x32_bf16 v[76:79], a[12:15], v[180:183], v[76:79]
    ds_read_b128 v[148:151], v244 offset:22528
    ds_read_b64_tr_b16 a[164:165], v205 offset:7808
    v_mfma_f32_16x16x32_bf16 v[80:83], a[16:19], v[180:183], v[80:83]
    v_mfma_f32_16x16x32_bf16 v[84:87], a[20:23], v[180:183], v[84:87]
    buffer_load_dwordx4 v[16:19], v2, s[20:23], s39 offen offset:2048 sc1
    v_mfma_f32_16x16x32_bf16 v[88:91], a[12:15], v[184:187], v[88:91]
    ds_read_b128 v[152:155], v244 offset:24576
    ds_read_b64_tr_b16 a[166:167], v205 offset:8576
    v_mfma_f32_16x16x32_bf16 v[92:95], a[16:19], v[184:187], v[92:95]
    v_mfma_f32_16x16x32_bf16 v[96:99], a[20:23], v[184:187], v[96:99]
    v_mfma_f32_16x16x32_bf16 v[100:103], a[12:15], v[188:191], v[100:103]
    ds_read_b128 v[156:159], v244 offset:26624
    ds_read_b64_tr_b16 a[168:169], v254 offset:15616
    buffer_load_dwordx4 v[20:23], v2, s[20:23], s39 offen offset:3072 sc1
    v_mfma_f32_16x16x32_bf16 v[104:107], a[16:19], v[188:191], v[104:107]
    v_mfma_f32_16x16x32_bf16 v[108:111], a[20:23], v[188:191], v[108:111]
    v_mfma_f32_16x16x32_bf16 v[112:115], a[12:15], v[192:195], v[112:115]
    ds_read_b128 v[160:163], v244 offset:28672
    ds_read_b64_tr_b16 a[170:171], v254 offset:16384
    v_mfma_f32_16x16x32_bf16 v[116:119], a[16:19], v[192:195], v[116:119]
    s_mov_b32 s39, 8192
    buffer_load_dwordx4 v[24:27], v2, s[20:23], s39 offen offset:0 sc1
    v_mfma_f32_16x16x32_bf16 v[120:123], a[20:23], v[192:195], v[120:123]
    s_waitcnt lgkmcnt(15)
    v_mfma_f32_16x16x32_bf16 v[124:127], a[12:15], v[196:199], v[124:127]
    ds_read_b128 v[164:167], v244 offset:30720
    ds_read_b64_tr_b16 a[172:173], v254 offset:46960
    v_mfma_f32_16x16x32_bf16 v[128:131], a[16:19], v[196:199], v[128:131]
    v_mfma_f32_16x16x32_bf16 v[132:135], a[20:23], v[196:199], v[132:135]
    buffer_load_dwordx4 v[28:31], v2, s[20:23], s39 offen offset:1024 sc1
    s_waitcnt lgkmcnt(15)
    v_mfma_f32_16x16x32_bf16 v[40:43], a[24:27], v[136:139], v[40:43]
    ds_read_b128 v[168:171], v245 offset:16384
    ds_read_b64_tr_b16 a[174:175], v254 offset:47728
    v_mfma_f32_16x16x32_bf16 v[44:47], a[28:31], v[136:139], v[44:47]
    v_mfma_f32_16x16x32_bf16 v[48:51], a[32:35], v[136:139], v[48:51]
    s_waitcnt lgkmcnt(15)
    v_mfma_f32_16x16x32_bf16 v[52:55], a[24:27], v[140:143], v[52:55]
    ds_read_b128 v[172:175], v245 offset:18432
    ds_read_b64_tr_b16 a[176:177], v205 offset:15616
    buffer_load_dwordx4 v[32:35], v2, s[20:23], s39 offen offset:2048 sc1
    v_mfma_f32_16x16x32_bf16 v[56:59], a[28:31], v[140:143], v[56:59]
    v_mfma_f32_16x16x32_bf16 v[60:63], a[32:35], v[140:143], v[60:63]
    s_waitcnt lgkmcnt(15)
    v_mfma_f32_16x16x32_bf16 v[64:67], a[24:27], v[144:147], v[64:67]
    ds_read_b128 v[176:179], v245 offset:20480
    ds_read_b64_tr_b16 a[178:179], v205 offset:16384
    v_mfma_f32_16x16x32_bf16 v[68:71], a[28:31], v[144:147], v[68:71]
    buffer_load_dwordx4 v[36:39], v2, s[20:23], s39 offen offset:3072 sc1
    v_mfma_f32_16x16x32_bf16 v[72:75], a[32:35], v[144:147], v[72:75]
    s_waitcnt lgkmcnt(15)
    v_mfma_f32_16x16x32_bf16 v[76:79], a[24:27], v[148:151], v[76:79]
    ds_read_b128 v[180:183], v245 offset:22528
    ds_read_b64_tr_b16 a[180:181], v254 offset:23424
    v_mfma_f32_16x16x32_bf16 v[80:83], a[28:31], v[148:151], v[80:83]
    v_mfma_f32_16x16x32_bf16 v[84:87], a[32:35], v[148:151], v[84:87]
    s_mov_b32 s39, 12288
    buffer_load_dwordx4 a[0:3], v2, s[20:23], s39 offen offset:0 sc1
    s_waitcnt lgkmcnt(15)
    v_mfma_f32_16x16x32_bf16 v[88:91], a[24:27], v[152:155], v[88:91]
    ds_read_b128 v[184:187], v245 offset:24576
    ds_read_b64_tr_b16 a[182:183], v254 offset:24192
    v_mfma_f32_16x16x32_bf16 v[92:95], a[28:31], v[152:155], v[92:95]
    v_mfma_f32_16x16x32_bf16 v[96:99], a[32:35], v[152:155], v[96:99]
    s_waitcnt lgkmcnt(15)
    v_mfma_f32_16x16x32_bf16 v[100:103], a[24:27], v[156:159], v[100:103]
    ds_read_b128 v[188:191], v245 offset:26624
    ds_read_b64_tr_b16 a[184:185], v254 offset:54768
    buffer_load_dwordx4 a[4:7], v2, s[20:23], s39 offen offset:1024 sc1
    v_mfma_f32_16x16x32_bf16 v[104:107], a[28:31], v[156:159], v[104:107]
    v_mfma_f32_16x16x32_bf16 v[108:111], a[32:35], v[156:159], v[108:111]
    s_waitcnt vmcnt(12)
    s_mov_b32 s34, 16384
Lf3:
    v_xor_b32 v252, s8, v252
    v_xor_b32 v253, s9, v253
    v_or_b32 v252, v252, v253
    v_cmp_ne_u32 vcc, 0, v252
    s_nop 0
    s_cmp_eq_u64 vcc, 0
    s_cbranch_scc1 Lf3_x
    buffer_load_dwordx2 v[252:253], v243, s[16:19], s53 offen sc1
    s_waitcnt vmcnt(0)
    s_sub_u32 s34, s34, 1
    s_cbranch_scc0 Lf3
Lf3_x:
    s_waitcnt lgkmcnt(15)
    v_mfma_f32_16x16x32_bf16 v[112:115], a[24:27], v[160:163], v[112:115]
    ds_read_b128 v[192:195], v245 offset:28672
    ds_read_b64_tr_b16 a[186:187], v254 offset:55536
    v_mfma_f32_16x16x32_bf16 v[116:119], a[28:31], v[160:163], v[116:119]
    buffer_load_dwordx4 a[8:11], v2, s[20:23], s39 offen offset:2048 sc1
    v_mfma_f32_16x16x32_bf16 v[120:123], a[32:35], v[160:163], v[120:123]
    s_waitcnt lgkmcnt(15)
    v_mfma_f32_16x16x32_bf16 v[124:127], a[24:27], v[164:167], v[124:127]
    ds_read_b128 v[196:199], v245 offset:30720
    ds_read_b64_tr_b16 a[188:189], v205 offset:23424
    v_mfma_f32_16x16x32_bf16 v[128:131], a[28:31], v[164:167], v[128:131]
    v_mfma_f32_16x16x32_bf16 v[132:135], a[32:35], v[164:167], v[132:135]
    v_add_u32 v232, 128, v232
    s_add_u32 m0, s38, 49152
    s_waitcnt lgkmcnt(15)
    v_mfma_f32_16x16x32_bf16 v[40:43], a[36:39], v[168:171], v[40:43]
    ds_read_b128 v[136:139], v244 offset:32768
    buffer_load_dwordx4 v232, s[16:19], s44 offen sc1 lds
    ds_read_b64_tr_b16 a[190:191], v205 offset:24192
    v_mfma_f32_16x16x32_bf16 v[44:47], a[40:43], v[168:171], v[44:47]
    v_mfma_f32_16x16x32_bf16 v[48:51], a[44:47], v[168:171], v[48:51]
    s_waitcnt lgkmcnt(15)
    v_mfma_f32_16x16x32_bf16 v[52:55], a[36:39], v[172:175], v[52:55]
    ds_read_b128 v[140:143], v244 offset:34816
    ds_read_b64_tr_b16 a[218:219], v211 offset:0
    s_add_u32 m0, s38, 50176
    v_mfma_f32_16x16x32_bf16 v[56:59], a[40:43], v[172:175], v[56:59]
    buffer_load_dwordx4 v232, s[16:19], s45 offen sc1 lds
    v_mfma_f32_16x16x32_bf16 v[60:63], a[44:47], v[172:175], v[60:63]
    s_add_u32 m0, s38, 51200
    s_nop 0
    buffer_load_dwordx4 v232, s[16:19], s46 offen sc1 lds
    s_add_u32 m0, s38, 52224
    s_waitcnt lgkmcnt(15)
    v_mfma_f32_16x16x32_bf16 v[64:67], a[36:39], v[176:179], v[64:67]
    ds_read_b128 v[144:147], v244 offset:36864
    buffer_load_dwordx4 v232, s[16:19], s47 offen sc1 lds
    ds_read_b64_tr_b16 a[222:223], v211 offset:31344
    v_mfma_f32_16x16x32_bf16 v[68:71], a[40:43], v[176:179], v[68:71]
    v_mfma_f32_16x16x32_bf16 v[72:75], a[44:47], v[176:179], v[72:75]
    s_waitcnt lgkmcnt(15)
    v_mfma_f32_16x16x32_bf16 v[76:79], a[36:39], v[180:183], v[76:79]
    ds_read_b128 v[148:151], v244 offset:38912
    ds_read_b64_tr_b16 a[226:227], v222 offset:0
    v_add_u32 v232, 128, v232
    s_add_u32 m0, s38, 65536
    v_mfma_f32_16x16x32_bf16 v[80:83], a[40:43], v[180:183], v[80:83]
    buffer_load_dwordx4 v232, s[16:19], s44 offen sc1 lds
    v_mfma_f32_16x16x32_bf16 v[84:87], a[44:47], v[180:183], v[84:87]
    s_waitcnt lgkmcnt(15)
    v_mfma_f32_16x16x32_bf16 v[88:91], a[36:39], v[184:187], v[88:91]
    ds_read_b128 v[152:155], v244 offset:40960
    ds_read_b64_tr_b16 a[230:231], v211 offset:15616
    v_mfma_f32_16x16x32_bf16 v[92:95], a[40:43], v[184:187], v[92:95]
    s_add_u32 m0, s38, 66560
    v_mfma_f32_16x16x32_bf16 v[96:99], a[44:47], v[184:187], v[96:99]
    buffer_load_dwordx4 v232, s[16:19], s45 offen sc1 lds
    s_waitcnt lgkmcnt(15)
    v_mfma_f32_16x16x32_bf16 v[100:103], a[36:39], v[188:191], v[100:103]
    ds_read_b128 v[156:159], v244 offset:43008
    ds_read_b64_tr_b16 a[234:235], v211 offset:46960
    v_mfma_f32_16x16x32_bf16 v[104:107], a[40:43], v[188:191], v[104:107]
    v_mfma_f32_16x16x32_bf16 v[108:111], a[44:47], v[188:191], v[108:111]
    s_add_u32 m0, s38, 67584
    s_waitcnt lgkmcnt(15)
    v_mfma_f32_16x16x32_bf16 v[112:115], a[36:39], v[192:195], v[112:115]
    ds_read_b128 v[160:163], v244 offset:45056
    buffer_load_dwordx4 v232, s[16:19], s46 offen sc1 lds
    ds_read_b64_tr_b16 a[238:239], v222 offset:15616
    v_mfma_f32_16x16x32_bf16 v[116:119], a[40:43], v[192:195], v[116:119]
    v_mfma_f32_16x16x32_bf16 v[120:123], a[44:47], v[192:195], v[120:123]
    s_waitcnt lgkmcnt(15)
    v_mfma_f32_16x16x32_bf16 v[124:127], a[36:39], v[196:199], v[124:127]
    ds_read_b128 v[164:167], v244 offset:47104
    s_add_u32 m0, s38, 68608
    v_mfma_f32_16x16x32_bf16 v[128:131], a[40:43], v[196:199], v[128:131]
    buffer_load_dwordx4 v232, s[16:19], s47 offen sc1 lds
    v_mfma_f32_16x16x32_bf16 v[132:135], a[44:47], v[196:199], v[132:135]
    s_waitcnt lgkmcnt(14)
    v_mfma_f32_16x16x32_bf16 v[40:43], a[48:51], v[136:139], v[40:43]
    ds_read_b128 v[168:171], v245 offset:32768
    v_mfma_f32_16x16x32_bf16 v[44:47], a[52:55], v[136:139], v[44:47]
    v_add_u32 v232, 128, v232
    s_add_u32 m0, s38, 81920
    v_mfma_f32_16x16x32_bf16 v[48:51], a[56:59], v[136:139], v[48:51]
    buffer_load_dwordx4 v232, s[16:19], s44 offen sc1 lds
    s_waitcnt lgkmcnt(13)
    v_mfma_f32_16x16x32_bf16 v[52:55], a[48:51], v[140:143], v[52:55]
    ds_read_b128 v[172:175], v245 offset:34816
    v_mfma_f32_16x16x32_bf16 v[56:59], a[52:55], v[140:143], v[56:59]
    v_mfma_f32_16x16x32_bf16 v[60:63], a[56:59], v[140:143], v[60:63]
    s_add_u32 m0, s38, 82944
    s_waitcnt lgkmcnt(12)
    v_mfma_f32_16x16x32_bf16 v[64:67], a[48:51], v[144:147], v[64:67]
    ds_read_b128 v[176:179], v245 offset:36864
    buffer_load_dwordx4 v232, s[16:19], s45 offen sc1 lds
    v_mfma_f32_16x16x32_bf16 v[68:71], a[52:55], v[144:147], v[68:71]
    v_mfma_f32_16x16x32_bf16 v[72:75], a[56:59], v[144:147], v[72:75]
    s_waitcnt lgkmcnt(11)
    v_mfma_f32_16x16x32_bf16 v[76:79], a[48:51], v[148:151], v[76:79]
    ds_read_b128 v[180:183], v245 offset:38912
    s_add_u32 m0, s38, 83968
    v_mfma_f32_16x16x32_bf16 v[80:83], a[52:55], v[148:151], v[80:83]
    buffer_load_dwordx4 v232, s[16:19], s46 offen sc1 lds
    v_mfma_f32_16x16x32_bf16 v[84:87], a[56:59], v[148:151], v[84:87]
    s_waitcnt lgkmcnt(10)
    v_mfma_f32_16x16x32_bf16 v[88:91], a[48:51], v[152:155], v[88:91]
    ds_read_b128 v[184:187], v245 offset:40960
    v_mfma_f32_16x16x32_bf16 v[92:95], a[52:55], v[152:155], v[92:95]
    s_add_u32 m0, s38, 84992
    v_mfma_f32_16x16x32_bf16 v[96:99], a[56:59], v[152:155], v[96:99]
    buffer_load_dwordx4 v232, s[16:19], s47 offen sc1 lds
    s_waitcnt lgkmcnt(9)
    v_mfma_f32_16x16x32_bf16 v[100:103], a[48:51], v[156:159], v[100:103]
    ds_read_b128 v[188:191], v245 offset:43008
    v_mfma_f32_16x16x32_bf16 v[104:107], a[52:55], v[156:159], v[104:107]
    v_mfma_f32_16x16x32_bf16 v[108:111], a[56:59], v[156:159], v[108:111]
    buffer_load_dwordx4 a[12:15], v2, s[20:23], s39 offen offset:3072 sc1
    s_waitcnt lgkmcnt(8)
    v_mfma_f32_16x16x32_bf16 v[112:115], a[48:51], v[160:163], v[112:115]
    ds_read_b128 v[192:195], v245 offset:45056
    v_mfma_f32_16x16x32_bf16 v[116:119], a[52:55], v[160:163], v[116:119]
    v_mfma_f32_16x16x32_bf16 v[120:123], a[56:59], v[160:163], v[120:123]
    s_waitcnt lgkmcnt(7)
    v_mfma_f32_16x16x32_bf16 v[124:127], a[48:51], v[164:167], v[124:127]
    ds_read_b128 v[196:199], v245 offset:47104
    s_mov_b32 s39, 16384
    buffer_load_dwordx4 a[16:19], v2, s[20:23], s39 offen offset:0 sc1
    v_mfma_f32_16x16x32_bf16 v[128:131], a[52:55], v[164:167], v[128:131]
    v_mfma_f32_16x16x32_bf16 v[132:135], a[56:59], v[164:167], v[132:135]
    s_waitcnt vmcnt(10)
    s_barrier
    s_waitcnt lgkmcnt(7)
    v_mfma_f32_16x16x32_bf16 v[40:43], a[60:63], v[168:171], v[40:43]
    ds_read_b128 v[136:139], v244 offset:49152
    v_mfma_f32_16x16x32_bf16 v[44:47], a[64:67], v[168:171], v[44:47]
    buffer_load_dwordx4 a[20:23], v2, s[20:23], s39 offen offset:1024 sc1
    v_mfma_f32_16x16x32_bf16 v[48:51], a[68:71], v[168:171], v[48:51]
    s_waitcnt lgkmcnt(7)
    v_mfma_f32_16x16x32_bf16 v[52:55], a[60:63], v[172:175], v[52:55]
    ds_read_b128 v[140:143], v244 offset:51200
    v_mfma_f32_16x16x32_bf16 v[56:59], a[64:67], v[172:175], v[56:59]
    v_mfma_f32_16x16x32_bf16 v[60:63], a[68:71], v[172:175], v[60:63]
    v_add_u32 v232, 128, v232
    s_add_u32 m0, s38, 0
    s_waitcnt lgkmcnt(7)
    v_mfma_f32_16x16x32_bf16 v[64:67], a[60:63], v[176:179], v[64:67]
    ds_read_b128 v[144:147], v244 offset:53248
    buffer_load_dwordx4 v232, s[16:19], s44 offen sc1 lds
    v_mfma_f32_16x16x32_bf16 v[68:71], a[64:67], v[176:179], v[68:71]
    v_mfma_f32_16x16x32_bf16 v[72:75], a[68:71], v[176:179], v[72:75]
    s_waitcnt lgkmcnt(7)
    v_mfma_f32_16x16x32_bf16 v[76:79], a[60:63], v[180:183], v[76:79]
    ds_read_b128 v[148:151], v244 offset:55296
    s_add_u32 m0, s38, 1024
    v_mfma_f32_16x16x32_bf16 v[80:83], a[64:67], v[180:183], v[80:83]
    buffer_load_dwordx4 v232, s[16:19], s45 offen sc1 lds
    v_mfma_f32_16x16x32_bf16 v[84:87], a[68:71], v[180:183], v[84:87]
    s_waitcnt lgkmcnt(7)
    v_mfma_f32_16x16x32_bf16 v[88:91], a[60:63], v[184:187], v[88:91]
    ds_read_b128 v[152:155], v244 offset:57344
    v_mfma_f32_16x16x32_bf16 v[92:95], a[64:67], v[184:187], v[92:95]
    s_add_u32 m0, s38, 2048
    v_mfma_f32_16x16x32_bf16 v[96:99], a[68:71], v[184:187], v[96:99]
    buffer_load_dwordx4 v232, s[16:19], s46 offen sc1 lds
    s_waitcnt lgkmcnt(7)
    v_mfma_f32_16x16x32_bf16 v[100:103], a[60:63], v[188:191], v[100:103]
    ds_read_b128 v[156:159], v244 offset:59392
    v_mfma_f32_16x16x32_bf16 v[104:107], a[64:67], v[188:191], v[104:107]
    v_mfma_f32_16x16x32_bf16 v[108:111], a[68:71], v[188:191], v[108:111]
    s_add_u32 m0, s38, 3072
    s_waitcnt lgkmcnt(7)
    v_mfma_f32_16x16x32_bf16 v[112:115], a[60:63], v[192:195], v[112:115]
    ds_read_b128 v[160:163], v244 offset:61440
    buffer_load_dwordx4 v232, s[16:19], s47 offen sc1 lds
    v_mfma_f32_16x16x32_bf16 v[116:119], a[64:67], v[192:195], v[116:119]
    v_mfma_f32_16x16x32_bf16 v[120:123], a[68:71], v[192:195], v[120:123]
    s_waitcnt lgkmcnt(7)
    v_mfma_f32_16x16x32_bf16 v[124:127], a[60:63], v[196:199], v[124:127]
    ds_read_b128 v[164:167], v244 offset:63488
    v_add_u32 v232, 128, v232
    s_add_u32 m0, s38, 16384
    v_mfma_f32_16x16x32_bf16 v[128:131], a[64:67], v[196:199], v[128:131]
    buffer_load_dwordx4 v232, s[16:19], s44 offen sc1 lds
    v_mfma_f32_16x16x32_bf16 v[132:135], a[68:71], v[196:199], v[132:135]
    s_waitcnt lgkmcnt(7)
    v_mfma_f32_16x16x32_bf16 v[40:43], a[72:75], v[136:139], v[40:43]
    ds_read_b128 v[168:171], v245 offset:49152
    v_mfma_f32_16x16x32_bf16 v[44:47], a[76:79], v[136:139], v[44:47]
    s_add_u32 m0, s38, 17408
    v_mfma_f32_16x16x32_bf16 v[48:51], a[80:83], v[136:139], v[48:51]
    buffer_load_dwordx4 v232, s[16:19], s45 offen sc1 lds
    s_waitcnt lgkmcnt(7)
    v_mfma_f32_16x16x32_bf16 v[52:55], a[72:75], v[140:143], v[52:55]
    ds_read_b128 v[172:175], v245 offset:51200
    v_mfma_f32_16x16x32_bf16 v[56:59], a[76:79], v[140:143], v[56:59]
    v_mfma_f32_16x16x32_bf16 v[60:63], a[80:83], v[140:143], v[60:63]
    s_add_u32 m0, s38, 18432
    s_waitcnt lgkmcnt(7)
    v_mfma_f32_16x16x32_bf16 v[64:67], a[72:75], v[144:147], v[64:67]
    ds_read_b128 v[176:179], v245 offset:53248
    buffer_load_dwordx4 v232, s[16:19], s46 offen sc1 lds
    v_mfma_f32_16x16x32_bf16 v[68:71], a[76:79], v[144:147], v[68:71]
    v_mfma_f32_16x16x32_bf16 v[72:75], a[80:83], v[144:147], v[72:75]
    s_waitcnt lgkmcnt(7)
    v_mfma_f32_16x16x32_bf16 v[76:79], a[72:75], v[148:151], v[76:79]
    ds_read_b128 v[180:183], v245 offset:55296
    s_add_u32 m0, s38, 19456
    v_mfma_f32_16x16x32_bf16 v[80:83], a[76:79], v[148:151], v[80:83]
    buffer_load_dwordx4 v232, s[16:19], s47 offen sc1 lds
    v_mfma_f32_16x16x32_bf16 v[84:87], a[80:83], v[148:151], v[84:87]
    s_waitcnt lgkmcnt(7)
    v_mfma_f32_16x16x32_bf16 v[88:91], a[72:75], v[152:155], v[88:91]
    ds_read_b128 v[184:187], v245 offset:57344
    v_mfma_f32_16x16x32_bf16 v[92:95], a[76:79], v[152:155], v[92:95]
    s_add_u32 m0, s54, 0
    s_mov_b32 s55, 46080
    buffer_load_dwordx4 v2, s[20:23], s55 offen sc1 lds
    v_mfma_f32_16x16x32_bf16 v[96:99], a[80:83], v[152:155], v[96:99]
    s_waitcnt lgkmcnt(7)
    v_mfma_f32_16x16x32_bf16 v[100:103], a[72:75], v[156:159], v[100:103]
    ds_read_b128 v[188:191], v245 offset:59392
    v_mfma_f32_16x16x32_bf16 v[104:107], a[76:79], v[156:159], v[104:107]
    v_mfma_f32_16x16x32_bf16 v[108:111], a[80:83], v[156:159], v[108:111]
    s_add_u32 m0, s54, 1024
    s_mov_b32 s55, 47104
    buffer_load_dwordx4 v2, s[20:23], s55 offen sc1 lds
    s_waitcnt lgkmcnt(7)
    v_mfma_f32_16x16x32_bf16 v[112:115], a[72:75], v[160:163], v[112:115]
    ds_read_b128 v[192:195], v245 offset:61440
    v_mfma_f32_16x16x32_bf16 v[116:119], a[76:79], v[160:163], v[116:119]
    v_mfma_f32_16x16x32_bf16 v[120:123], a[80:83], v[160:163], v[120:123]
    s_waitcnt lgkmcnt(7)
    v_mfma_f32_16x16x32_bf16 v[124:127], a[72:75], v[164:167], v[124:127]
    ds_read_b128 v[196:199], v245 offset:63488
    s_add_u32 m0, s54, 2048
    s_mov_b32 s55, 48128
    buffer_load_dwordx4 v2, s[20:23], s55 offen sc1 lds
    v_mfma_f32_16x16x32_bf16 v[128:131], a[76:79], v[164:167], v[128:131]
    v_mfma_f32_16x16x32_bf16 v[132:135], a[80:83], v[164:167], v[132:135]
    s_waitcnt vmcnt(18)
    s_barrier
    s_waitcnt lgkmcnt(7)
    v_mfma_f32_16x16x32_bf16 v[40:43], a[84:87], v[168:171], v[40:43]
    ds_read_b128 v[136:139], v246 offset:0
    v_mfma_f32_16x16x32_bf16 v[44:47], a[88:91], v[168:171], v[44:47]
    s_add_u32 m0, s54, 3072
    s_mov_b32 s55, 49152
    buffer_load_dwordx4 v2, s[20:23], s55 offen sc1 lds
    v_mfma_f32_16x16x32_bf16 v[48:51], a[92:95], v[168:171], v[48:51]
    s_waitcnt lgkmcnt(7)
    v_mfma_f32_16x16x32_bf16 v[52:55], a[84:87], v[172:175], v[52:55]
    ds_read_b128 v[140:143], v246 offset:2048
    v_mfma_f32_16x16x32_bf16 v[56:59], a[88:91], v[172:175], v[56:59]
    v_mfma_f32_16x16x32_bf16 v[60:63], a[92:95], v[172:175], v[60:63]
    v_add_u32 v232, 128, v232
    s_add_u32 m0, s38, 32768
    s_waitcnt lgkmcnt(7)
    v_mfma_f32_16x16x32_bf16 v[64:67], a[84:87], v[176:179], v[64:67]
    ds_read_b128 v[144:147], v246 offset:4096
    buffer_load_dwordx4 v232, s[16:19], s44 offen sc1 lds
    v_mfma_f32_16x16x32_bf16 v[68:71], a[88:91], v[176:179], v[68:71]
    v_mfma_f32_16x16x32_bf16 v[72:75], a[92:95], v[176:179], v[72:75]
    s_waitcnt lgkmcnt(7)
    v_mfma_f32_16x16x32_bf16 v[76:79], a[84:87], v[180:183], v[76:79]
    ds_read_b128 v[148:151], v246 offset:6144
    s_add_u32 m0, s38, 33792
    v_mfma_f32_16x16x32_bf16 v[80:83], a[88:91], v[180:183], v[80:83]
    buffer_load_dwordx4 v232, s[16:19], s45 offen sc1 lds
    v_mfma_f32_16x16x32_bf16 v[84:87], a[92:95], v[180:183], v[84:87]
    s_waitcnt lgkmcnt(7)
    v_mfma_f32_16x16x32_bf16 v[88:91], a[84:87], v[184:187], v[88:91]
    ds_read_b128 v[152:155], v246 offset:8192
    v_mfma_f32_16x16x32_bf16 v[92:95], a[88:91], v[184:187], v[92:95]
    s_add_u32 m0, s38, 34816
    v_mfma_f32_16x16x32_bf16 v[96:99], a[92:95], v[184:187], v[96:99]
    buffer_load_dwordx4 v232, s[16:19], s46 offen sc1 lds
    s_waitcnt lgkmcnt(7)
    v_mfma_f32_16x16x32_bf16 v[100:103], a[84:87], v[188:191], v[100:103]
    ds_read_b128 v[156:159], v246 offset:10240
    v_mfma_f32_16x16x32_bf16 v[104:107], a[88:91], v[188:191], v[104:107]
    v_mfma_f32_16x16x32_bf16 v[108:111], a[92:95], v[188:191], v[108:111]
    s_add_u32 m0, s38, 35840
    s_waitcnt lgkmcnt(7)
    v_mfma_f32_16x16x32_bf16 v[112:115], a[84:87], v[192:195], v[112:115]
    ds_read_b128 v[160:163], v246 offset:12288
    buffer_load_dwordx4 v232, s[16:19], s47 offen sc1 lds
    v_mfma_f32_16x16x32_bf16 v[116:119], a[88:91], v[192:195], v[116:119]
    v_mfma_f32_16x16x32_bf16 v[120:123], a[92:95], v[192:195], v[120:123]
    s_waitcnt lgkmcnt(7)
    v_mfma_f32_16x16x32_bf16 v[124:127], a[84:87], v[196:199], v[124:127]
    ds_read_b128 v[164:167], v246 offset:14336
    s_add_u32 m0, s54, 4096
    s_mov_b32 s55, 50176
    buffer_load_dwordx4 v2, s[20:23], s55 offen sc1 lds
    v_mfma_f32_16x16x32_bf16 v[128:131], a[88:91], v[196:199], v[128:131]
    v_mfma_f32_16x16x32_bf16 v[132:135], a[92:95], v[196:199], v[132:135]
    s_waitcnt vmcnt(43)
    s_mov_b64 exec, 1
    buffer_atomic_swap_x2 v[240:241], v242, s[16:19], s41 offen sc1
    s_mov_b64 exec, -1
    s_waitcnt lgkmcnt(7)
    v_mfma_f32_16x16x32_bf16 v[40:43], a[96:99], v[136:139], v[40:43]
    ds_read_b128 v[168:171], v247 offset:0
    v_mfma_f32_16x16x32_bf16 v[44:47], a[100:103], v[136:139], v[44:47]
    s_add_u32 m0, s54, 5120
    s_mov_b32 s55, 51200
    buffer_load_dwordx4 v2, s[20:23], s55 offen sc1 lds
    v_mfma_f32_16x16x32_bf16 v[48:51], a[104:107], v[136:139], v[48:51]
    s_waitcnt lgkmcnt(7)
    v_mfma_f32_16x16x32_bf16 v[52:55], a[96:99], v[140:143], v[52:55]
    ds_read_b128 v[172:175], v247 offset:2048
    v_mfma_f32_16x16x32_bf16 v[56:59], a[100:103], v[140:143], v[56:59]
    v_mfma_f32_16x16x32_bf16 v[60:63], a[104:107], v[140:143], v[60:63]
    s_add_u32 m0, s54, 6144
    s_mov_b32 s55, 52224
    buffer_load_dwordx4 v2, s[20:23], s55 offen sc1 lds
    s_waitcnt lgkmcnt(7)
    v_mfma_f32_16x16x32_bf16 v[64:67], a[96:99], v[144:147], v[64:67]
    ds_read_b128 v[176:179], v247 offset:4096
    v_mfma_f32_16x16x32_bf16 v[68:71], a[100:103], v[144:147], v[68:71]
    v_mfma_f32_16x16x32_bf16 v[72:75], a[104:107], v[144:147], v[72:75]
    s_waitcnt lgkmcnt(7)
    v_mfma_f32_16x16x32_bf16 v[76:79], a[96:99], v[148:151], v[76:79]
    ds_read_b128 v[180:183], v247 offset:6144
    s_add_u32 m0, s54, 7168
    s_mov_b32 s55, 53248
    buffer_load_dwordx4 v2, s[20:23], s55 offen sc1 lds
    v_mfma_f32_16x16x32_bf16 v[80:83], a[100:103], v[148:151], v[80:83]
    v_mfma_f32_16x16x32_bf16 v[84:87], a[104:107], v[148:151], v[84:87]
    s_waitcnt lgkmcnt(7)
    v_mfma_f32_16x16x32_bf16 v[88:91], a[96:99], v[152:155], v[88:91]
    ds_read_b128 v[184:187], v247 offset:8192
    v_mfma_f32_16x16x32_bf16 v[92:95], a[100:103], v[152:155], v[92:95]
    s_add_u32 m0, s54, 8192
    s_mov_b32 s55, 54272
    buffer_load_dwordx4 v2, s[20:23], s55 offen sc1 lds
    v_mfma_f32_16x16x32_bf16 v[96:99], a[104:107], v[152:155], v[96:99]
    s_waitcnt lgkmcnt(7)
    v_mfma_f32_16x16x32_bf16 v[100:103], a[96:99], v[156:159], v[100:103]
    ds_read_b128 v[188:191], v247 offset:10240
    v_mfma_f32_16x16x32_bf16 v[104:107], a[100:103], v[156:159], v[104:107]
    v_mfma_f32_16x16x32_bf16 v[108:111], a[104:107], v[156:159], v[108:111]
    s_add_u32 m0, s54, 9216
    s_mov_b32 s55, 55296
    buffer_load_dwordx4 v2, s[20:23], s55 offen sc1 lds
    s_waitcnt lgkmcnt(7)
    v_mfma_f32_16x16x32_bf16 v[112:115], a[96:99], v[160:163], v[112:115]
    ds_read_b128 v[192:195], v247 offset:12288
    v_mfma_f32_16x16x32_bf16 v[116:119], a[100:103], v[160:163], v[116:119]
    v_mfma_f32_16x16x32_bf16 v[120:123], a[104:107], v[160:163], v[120:123]
    s_waitcnt lgkmcnt(7)
    v_mfma_f32_16x16x32_bf16 v[124:127], a[96:99], v[164:167], v[124:127]
    ds_read_b128 v[196:199], v247 offset:14336
    s_add_u32 m0, s54, 10240
    s_mov_b32 s55, 56320
    buffer_load_dwordx4 v2, s[20:23], s55 offen sc1 lds
    v_mfma_f32_16x16x32_bf16 v[128:131], a[100:103], v[164:167], v[128:131]
    v_mfma_f32_16x16x32_bf16 v[132:135], a[104:107], v[164:167], v[132:135]
    s_waitcnt vmcnt(27)
    s_barrier
    s_waitcnt lgkmcnt(7)
    v_mfma_f32_16x16x32_bf16 v[40:43], a[108:111], v[168:171], v[40:43]
    ds_read_b128 v[136:139], v246 offset:16384
    v_mfma_f32_16x16x32_bf16 v[44:47], a[112:115], v[168:171], v[44:47]
    s_add_u32 m0, s54, 11264
    s_mov_b32 s55, 57344
    buffer_load_dwordx4 v2, s[20:23], s55 offen sc1 lds
    v_mfma_f32_16x16x32_bf16 v[48:51], a[116:119], v[168:171], v[48:51]
    s_waitcnt lgkmcnt(7)
    v_mfma_f32_16x16x32_bf16 v[52:55], a[108:111], v[172:175], v[52:55]
    ds_read_b128 v[140:143], v246 offset:18432
    v_mfma_f32_16x16x32_bf16 v[56:59], a[112:115], v[172:175], v[56:59]
    v_mfma_f32_16x16x32_bf16 v[60:63], a[116:119], v[172:175], v[60:63]
    v_add_u32 v232, 128, v232
    s_add_u32 m0, s38, 49152
    s_waitcnt lgkmcnt(7)
    v_mfma_f32_16x16x32_bf16 v[64:67], a[108:111], v[176:179], v[64:67]
    ds_read_b128 v[144:147], v246 offset:20480
    buffer_load_dwordx4 v232, s[16:19], s44 offen sc1 lds
    v_mfma_f32_16x16x32_bf16 v[68:71], a[112:115], v[176:179], v[68:71]
    v_mfma_f32_16x16x32_bf16 v[72:75], a[116:119], v[176:179], v[72:75]
    s_waitcnt lgkmcnt(7)
    v_mfma_f32_16x16x32_bf16 v[76:79], a[108:111], v[180:183], v[76:79]
    ds_read_b128 v[148:151], v246 offset:22528
    s_add_u32 m0, s38, 50176
    v_mfma_f32_16x16x32_bf16 v[80:83], a[112:115], v[180:183], v[80:83]
    buffer_load_dwordx4 v232, s[16:19], s45 offen sc1 lds
    v_mfma_f32_16x16x32_bf16 v[84:87], a[116:119], v[180:183], v[84:87]
    s_waitcnt lgkmcnt(7)
    v_mfma_f32_16x16x32_bf16 v[88:91], a[108:111], v[184:187], v[88:91]
    ds_read_b128 v[152:155], v246 offset:24576
    v_mfma_f32_16x16x32_bf16 v[92:95], a[112:115], v[184:187], v[92:95]
    s_add_u32 m0, s38, 51200
    v_mfma_f32_16x16x32_bf16 v[96:99], a[116:119], v[184:187], v[96:99]
    buffer_load_dwordx4 v232, s[16:19], s46 offen sc1 lds
    s_waitcnt lgkmcnt(7)
    v_mfma_f32_16x16x32_bf16 v[100:103], a[108:111], v[188:191], v[100:103]
    ds_read_b128 v[156:159], v246 offset:26624
    v_mfma_f32_16x16x32_bf16 v[104:107], a[112:115], v[188:191], v[104:107]
    v_mfma_f32_16x16x32_bf16 v[108:111], a[116:119], v[188:191], v[108:111]
    s_add_u32 m0, s38, 52224
    s_waitcnt lgkmcnt(7)
    v_mfma_f32_16x16x32_bf16 v[112:115], a[108:111], v[192:195], v[112:115]
    ds_read_b128 v[160:163], v246 offset:28672
    buffer_load_dwordx4 v232, s[16:19], s47 offen sc1 lds
    v_mfma_f32_16x16x32_bf16 v[116:119], a[112:115], v[192:195], v[116:119]
    v_mfma_f32_16x16x32_bf16 v[120:123], a[116:119], v[192:195], v[120:123]
    s_waitcnt lgkmcnt(7)
    v_mfma_f32_16x16x32_bf16 v[124:127], a[108:111], v[196:199], v[124:127]
    ds_read_b128 v[164:167], v246 offset:30720
    s_add_u32 m0, s54, 12288
    s_mov_b32 s55, 58368
    buffer_load_dwordx4 v2, s[20:23], s55 offen sc1 lds
    v_mfma_f32_16x16x32_bf16 v[128:131], a[112:115], v[196:199], v[128:131]
    v_mfma_f32_16x16x32_bf16 v[132:135], a[116:119], v[196:199], v[132:135]
    s_waitcnt lgkmcnt(7)
    v_mfma_f32_16x16x32_bf16 v[40:43], a[120:123], v[136:139], v[40:43]
    ds_read_b128 v[168:171], v247 offset:16384
    v_mfma_f32_16x16x32_bf16 v[44:47], a[124:127], v[136:139], v[44:47]
    s_add_u32 m0, s54, 13312
    s_mov_b32 s55, 59392
    buffer_load_dwordx4 v2, s[20:23], s55 offen sc1 lds
    v_mfma_f32_16x16x32_bf16 v[48:51], a[128:131], v[136:139], v[48:51]
    s_waitcnt lgkmcnt(7)
    v_mfma_f32_16x16x32_bf16 v[52:55], a[120:123], v[140:143], v[52:55]
    ds_read_b128 v[172:175], v247 offset:18432
    v_mfma_f32_16x16x32_bf16 v[56:59], a[124:127], v[140:143], v[56:59]
    v_mfma_f32_16x16x32_bf16 v[60:63], a[128:131], v[140:143], v[60:63]
    s_add_u32 m0, s54, 14336
    s_mov_b32 s55, 60416
    buffer_load_dwordx4 v2, s[20:23], s55 offen sc1 lds
    s_waitcnt lgkmcnt(7)
    v_mfma_f32_16x16x32_bf16 v[64:67], a[120:123], v[144:147], v[64:67]
    ds_read_b128 v[176:179], v247 offset:20480
    v_mfma_f32_16x16x32_bf16 v[68:71], a[124:127], v[144:147], v[68:71]
    v_mfma_f32_16x16x32_bf16 v[72:75], a[128:131], v[144:147], v[72:75]
    s_waitcnt lgkmcnt(7)
    v_mfma_f32_16x16x32_bf16 v[76:79], a[120:123], v[148:151], v[76:79]
    ds_read_b128 v[180:183], v247 offset:22528
    buffer_load_dwordx4 a[24:27], v2, s[20:23], s39 offen offset:2048 sc1
    v_mfma_f32_16x16x32_bf16 v[80:83], a[124:127], v[148:151], v[80:83]
    v_mfma_f32_16x16x32_bf16 v[84:87], a[128:131], v[148:151], v[84:87]
    s_waitcnt lgkmcnt(7)
    v_mfma_f32_16x16x32_bf16 v[88:91], a[120:123], v[152:155], v[88:91]
    ds_read_b128 v[184:187], v247 offset:24576
    v_mfma_f32_16x16x32_bf16 v[92:95], a[124:127], v[152:155], v[92:95]
    buffer_load_dwordx4 a[28:31], v2, s[20:23], s39 offen offset:3072 sc1
    v_mfma_f32_16x16x32_bf16 v[96:99], a[128:131], v[152:155], v[96:99]
    s_waitcnt lgkmcnt(7)
    v_mfma_f32_16x16x32_bf16 v[100:103], a[120:123], v[156:159], v[100:103]
    ds_read_b128 v[188:191], v247 offset:26624
    v_mfma_f32_16x16x32_bf16 v[104:107], a[124:127], v[156:159], v[104:107]
    v_mfma_f32_16x16x32_bf16 v[108:111], a[128:131], v[156:159], v[108:111]
    s_mov_b32 s39, 20480
    buffer_load_dwordx4 a[32:35], v2, s[20:23], s39 offen offset:0 sc1
    s_waitcnt lgkmcnt(7)
    v_mfma_f32_16x16x32_bf16 v[112:115], a[120:123], v[160:163], v[112:115]
    ds_read_b128 v[192:195], v247 offset:28672
    v_mfma_f32_16x16x32_bf16 v[116:119], a[124:127], v[160:163], v[116:119]
    v_mfma_f32_16x16x32_bf16 v[120:123], a[128:131], v[160:163], v[120:123]
    s_waitcnt lgkmcnt(7)
    v_mfma_f32_16x16x32_bf16 v[124:127], a[120:123], v[164:167], v[124:127]
    ds_read_b128 v[196:199], v247 offset:30720
    buffer_load_dwordx4 a[36:39], v2, s[20:23], s39 offen offset:1024 sc1
    v_mfma_f32_16x16x32_bf16 v[128:131], a[124:127], v[164:167], v[128:131]
    v_mfma_f32_16x16x32_bf16 v[132:135], a[128:131], v[164:167], v[132:135]
    s_waitcnt vmcnt(28)
    s_barrier
    s_waitcnt lgkmcnt(7)
    v_mfma_f32_16x16x32_bf16 v[40:43], a[132:135], v[168:171], v[40:43]
    ds_read_b128 v[136:139], v244 offset:0
    v_mfma_f32_16x16x32_bf16 v[44:47], a[136:139], v[168:171], v[44:47]
    buffer_load_dwordx4 a[40:43], v2, s[20:23], s39 offen offset:2048 sc1
    v_mfma_f32_16x16x32_bf16 v[48:51], a[140:143], v[168:171], v[48:51]
    s_waitcnt lgkmcnt(7)
    v_mfma_f32_16x16x32_bf16 v[52:55], a[132:135], v[172:175], v[52:55]
    ds_read_b128 v[140:143], v244 offset:2048
    v_mfma_f32_16x16x32_bf16 v[56:59], a[136:139], v[172:175], v[56:59]
    v_mfma_f32_16x16x32_bf16 v[60:63], a[140:143], v[172:175], v[60:63]
    buffer_load_dwordx4 a[44:47], v2, s[20:23], s39 offen offset:3072 sc1
    s_waitcnt lgkmcnt(7)
    v_mfma_f32_16x16x32_bf16 v[64:67], a[132:135], v[176:179], v[64:67]
    ds_read_b128 v[144:147], v245 offset:0
    v_mfma_f32_16x16x32_bf16 v[68:71], a[136:139], v[176:179], v[68:71]
    v_mfma_f32_16x16x32_bf16 v[72:75], a[140:143], v[176:179], v[72:75]
    s_waitcnt lgkmcnt(7)
    v_mfma_f32_16x16x32_bf16 v[76:79], a[132:135], v[180:183], v[76:79]
    ds_read_b128 v[148:151], v245 offset:2048
    s_mov_b32 s39, 24576
    buffer_load_dwordx4 a[48:51], v2, s[20:23], s39 offen offset:0 sc1
    v_mfma_f32_16x16x32_bf16 v[80:83], a[136:139], v[180:183], v[80:83]
    v_mfma_f32_16x16x32_bf16 v[84:87], a[140:143], v[180:183], v[84:87]
    s_waitcnt lgkmcnt(7)
    v_mfma_f32_16x16x32_bf16 v[88:91], a[132:135], v[184:187], v[88:91]
    ds_read_b128 v[152:155], v244 offset:16384
    v_mfma_f32_16x16x32_bf16 v[92:95], a[136:139], v[184:187], v[92:95]
    buffer_load_dwordx4 a[52:55], v2, s[20:23], s39 offen offset:1024 sc1
    v_mfma_f32_16x16x32_bf16 v[96:99], a[140:143], v[184:187], v[96:99]
    s_waitcnt lgkmcnt(7)
    v_mfma_f32_16x16x32_bf16 v[100:103], a[132:135], v[188:191], v[100:103]
    ds_read_b128 v[156:159], v244 offset:18432
    v_mfma_f32_16x16x32_bf16 v[104:107], a[136:139], v[188:191], v[104:107]
    v_mfma_f32_16x16x32_bf16 v[108:111], a[140:143], v[188:191], v[108:111]
    buffer_load_dwordx4 a[56:59], v2, s[20:23], s39 offen offset:2048 sc1
    s_waitcnt lgkmcnt(7)
    v_mfma_f32_16x16x32_bf16 v[112:115], a[132:135], v[192:195], v[112:115]
    ds_read_b128 v[160:163], v245 offset:16384
    v_mfma_f32_16x16x32_bf16 v[116:119], a[136:139], v[192:195], v[116:119]
    v_mfma_f32_16x16x32_bf16 v[120:123], a[140:143], v[192:195], v[120:123]
    s_waitcnt lgkmcnt(7)
    v_mfma_f32_16x16x32_bf16 v[124:127], a[132:135], v[196:199], v[124:127]
    ds_read_b128 v[164:167], v245 offset:18432
    buffer_load_dwordx4 a[60:63], v2, s[20:23], s39 offen offset:3072 sc1
    v_mfma_f32_16x16x32_bf16 v[128:131], a[136:139], v[196:199], v[128:131]
    v_mfma_f32_16x16x32_bf16 v[132:135], a[140:143], v[196:199], v[132:135]
    s_waitcnt vmcnt(13)
    s_barrier
    s_waitcnt lgkmcnt(7)
    v_mfma_f32_16x16x32_bf16 v[40:43], a[144:147], v[136:139], v[40:43]
    ds_read_b128 v[168:171], v244 offset:32768
    v_mfma_f32_16x16x32_bf16 v[44:47], a[148:151], v[136:139], v[44:47]
    s_mov_b32 s39, 28672
    buffer_load_dwordx4 a[64:67], v2, s[20:23], s39 offen offset:0 sc1
    v_mfma_f32_16x16x32_bf16 v[48:51], a[152:155], v[136:139], v[48:51]
    s_waitcnt lgkmcnt(7)
    v_mfma_f32_16x16x32_bf16 v[52:55], a[144:147], v[140:143], v[52:55]
    ds_read_b128 v[172:175], v244 offset:34816
    v_mfma_f32_16x16x32_bf16 v[56:59], a[148:151], v[140:143], v[56:59]
    v_mfma_f32_16x16x32_bf16 v[60:63], a[152:155], v[140:143], v[60:63]
    buffer_load_dwordx4 a[68:71], v2, s[20:23], s39 offen offset:1024 sc1
    s_waitcnt lgkmcnt(7)
    v_mfma_f32_16x16x32_bf16 v[40:43], a[156:159], v[144:147], v[40:43]
    ds_read_b128 v[176:179], v245 offset:32768
    v_mfma_f32_16x16x32_bf16 v[44:47], a[160:163], v[144:147], v[44:47]
    v_mfma_f32_16x16x32_bf16 v[48:51], a[164:167], v[144:147], v[48:51]
    s_waitcnt lgkmcnt(7)
    v_mfma_f32_16x16x32_bf16 v[52:55], a[156:159], v[148:151], v[52:55]
    ds_read_b128 v[180:183], v245 offset:34816
    buffer_load_dwordx4 a[72:75], v2, s[20:23], s39 offen offset:2048 sc1
    v_mfma_f32_16x16x32_bf16 v[56:59], a[160:163], v[148:151], v[56:59]
    v_mfma_f32_16x16x32_bf16 v[60:63], a[164:167], v[148:151], v[60:63]
    s_waitcnt lgkmcnt(7)
    v_mfma_f32_16x16x32_bf16 v[40:43], a[168:171], v[152:155], v[40:43]
    ds_read_b128 v[184:187], v244 offset:49152
    buffer_load_dwordx2 v[252:253], v243, s[16:19], s63 offen sc1
    v_mfma_f32_16x16x32_bf16 v[44:47], a[172:175], v[152:155], v[44:47]
    v_mfma_f32_16x16x32_bf16 v[48:51], a[176:179], v[152:155], v[48:51]
    s_waitcnt lgkmcnt(7)
    v_mfma_f32_16x16x32_bf16 v[52:55], a[168:171], v[156:159], v[52:55]
    ds_read_b128 v[188:191], v244 offset:51200
    v_mfma_f32_16x16x32_bf16 v[56:59], a[172:175], v[156:159], v[56:59]
    buffer_load_dwordx4 a[76:79], v2, s[20:23], s39 offen offset:3072 sc1
    v_mfma_f32_16x16x32_bf16 v[60:63], a[176:179], v[156:159], v[60:63]
    s_waitcnt lgkmcnt(7)
    v_mfma_f32_16x16x32_bf16 v[40:43], a[180:183], v[160:163], v[40:43]
    ds_read_b128 v[192:195], v245 offset:49152
    v_mfma_f32_16x16x32_bf16 v[44:47], a[184:187], v[160:163], v[44:47]
    v_mfma_f32_16x16x32_bf16 v[48:51], a[188:191], v[160:163], v[48:51]
    s_mov_b32 s39, 32768
    buffer_load_dwordx4 a[80:83], v2, s[20:23], s39 offen offset:0 sc1
    s_waitcnt lgkmcnt(7)
    v_mfma_f32_16x16x32_bf16 v[52:55], a[180:183], v[164:167], v[52:55]
    ds_read_b128 v[196:199], v245 offset:51200
    v_mfma_f32_16x16x32_bf16 v[56:59], a[184:187], v[164:167], v[56:59]
    v_mfma_f32_16x16x32_bf16 v[60:63], a[188:191], v[164:167], v[60:63]
    s_waitcnt lgkmcnt(7)
    v_mfma_f32_16x16x32_bf16 v[40:43], a[192:195], v[168:171], v[40:43]
    ds_read_b128 v[136:139], v244 offset:4096
    buffer_load_dwordx4 a[84:87], v2, s[20:23], s39 offen offset:1024 sc1
    v_mfma_f32_16x16x32_bf16 v[44:47], a[196:199], v[168:171], v[44:47]
    v_mfma_f32_16x16x32_bf16 v[48:51], a[200:203], v[168:171], v[48:51]
    s_waitcnt lgkmcnt(7)
    v_mfma_f32_16x16x32_bf16 v[52:55], a[192:195], v[172:175], v[52:55]
    ds_read_b128 v[140:143], v244 offset:6144
    v_mfma_f32_16x16x32_bf16 v[56:59], a[196:199], v[172:175], v[56:59]
    buffer_load_dwordx4 a[88:91], v2, s[20:23], s39 offen offset:2048 sc1
    v_mfma_f32_16x16x32_bf16 v[60:63], a[200:203], v[172:175], v[60:63]
    s_waitcnt lgkmcnt(7)
    v_mfma_f32_16x16x32_bf16 v[40:43], a[204:207], v[176:179], v[40:43]
    ds_read_b128 v[144:147], v245 offset:4096
    v_mfma_f32_16x16x32_bf16 v[44:47], a[208:211], v[176:179], v[44:47]
    v_mfma_f32_16x16x32_bf16 v[48:51], a[212:215], v[176:179], v[48:51]
    buffer_load_dwordx4 a[92:95], v2, s[20:23], s39 offen offset:3072 sc1
    s_waitcnt lgkmcnt(7)
    v_mfma_f32_16x16x32_bf16 v[52:55], a[204:207], v[180:183], v[52:55]
    ds_read_b128 v[148:151], v245 offset:6144
    v_mfma_f32_16x16x32_bf16 v[56:59], a[208:211], v[180:183], v[56:59]
    v_mfma_f32_16x16x32_bf16 v[60:63], a[212:215], v[180:183], v[60:63]
    s_waitcnt lgkmcnt(7)
    v_mfma_f32_16x16x32_bf16 v[40:43], a[216:219], v[184:187], v[40:43]
    ds_read_b128 v[152:155], v244 offset:20480
    s_mov_b32 s39, 36864
    buffer_load_dwordx4 a[96:99], v2, s[20:23], s39 offen offset:0 sc1
    v_mfma_f32_16x16x32_bf16 v[44:47], a[220:223], v[184:187], v[44:47]
    v_mfma_f32_16x16x32_bf16 v[48:51], a[224:227], v[184:187], v[48:51]
    s_waitcnt lgkmcnt(7)
    v_mfma_f32_16x16x32_bf16 v[52:55], a[216:219], v[188:191], v[52:55]
    ds_read_b128 v[156:159], v244 offset:22528
    v_mfma_f32_16x16x32_bf16 v[56:59], a[220:223], v[188:191], v[56:59]
    buffer_load_dwordx4 a[100:103], v2, s[20:23], s39 offen offset:1024 sc1
    v_mfma_f32_16x16x32_bf16 v[60:63], a[224:227], v[188:191], v[60:63]
    s_waitcnt lgkmcnt(7)
    v_mfma_f32_16x16x32_bf16 v[40:43], a[228:231], v[192:195], v[40:43]
    ds_read_b128 v[160:163], v245 offset:20480
    v_mfma_f32_16x16x32_bf16 v[44:47], a[232:235], v[192:195], v[44:47]
    v_mfma_f32_16x16x32_bf16 v[48:51], a[236:239], v[192:195], v[48:51]
    buffer_load_dwordx4 a[104:107], v2, s[20:23], s39 offen offset:2048 sc1
    s_waitcnt lgkmcnt(7)
    v_mfma_f32_16x16x32_bf16 v[52:55], a[228:231], v[196:199], v[52:55]
    ds_read_b128 v[164:167], v245 offset:22528
    v_mfma_f32_16x16x32_bf16 v[56:59], a[232:235], v[196:199], v[56:59]
    v_mfma_f32_16x16x32_bf16 v[60:63], a[236:239], v[196:199], v[60:63]
    s_waitcnt lgkmcnt(7)
    v_mfma_f32_16x16x32_bf16 v[64:67], a[144:147], v[136:139], v[64:67]
    ds_read_b128 v[168:171], v244 offset:36864
    buffer_load_dwordx4 a[108:111], v2, s[20:23], s39 offen offset:3072 sc1
    v_mfma_f32_16x16x32_bf16 v[68:71], a[148:151], v[136:139], v[68:71]
    v_mfma_f32_16x16x32_bf16 v[72:75], a[152:155], v[136:139], v[72:75]
    s_waitcnt lgkmcnt(7)
    v_mfma_f32_16x16x32_bf16 v[76:79], a[144:147], v[140:143], v[76:79]
    ds_read_b128 v[172:175], v244 offset:38912
    v_permlane32_swap_b32 v48, v60
    v_mfma_f32_16x16x32_bf16 v[80:83], a[148:151], v[140:143], v[80:83]
    v_permlane32_swap_b32 v49, v61
    s_mov_b32 s39, 40960
    buffer_load_dwordx4 a[112:115], v2, s[20:23], s39 offen offset:0 sc1
    v_mfma_f32_16x16x32_bf16 v[84:87], a[152:155], v[140:143], v[84:87]
    v_permlane32_swap_b32 v50, v62
    s_waitcnt lgkmcnt(7)
    v_mfma_f32_16x16x32_bf16 v[64:67], a[156:159], v[144:147], v[64:67]
    ds_read_b128 v[176:179], v245 offset:36864
    v_permlane32_swap_b32 v51, v63
    v_mfma_f32_16x16x32_bf16 v[68:71], a[160:163], v[144:147], v[68:71]
    v_max_f32 v40, 0, v40
    v_mfma_f32_16x16x32_bf16 v[72:75], a[164:167], v[144:147], v[72:75]
    v_max_f32 v41, 0, v41
    buffer_load_dwordx4 a[116:119], v2, s[20:23], s39 offen offset:1024 sc1
    s_waitcnt lgkmcnt(7)
    v_mfma_f32_16x16x32_bf16 v[76:79], a[156:159], v[148:151], v[76:79]
    ds_read_b128 v[180:183], v245 offset:38912
    v_max_f32 v42, 0, v42
    v_mfma_f32_16x16x32_bf16 v[80:83], a[160:163], v[148:151], v[80:83]
    v_max_f32 v43, 0, v43
    v_mfma_f32_16x16x32_bf16 v[84:87], a[164:167], v[148:151], v[84:87]
    v_max_f32 v52, 0, v52
    s_waitcnt lgkmcnt(7)
    v_mfma_f32_16x16x32_bf16 v[64:67], a[168:171], v[152:155], v[64:67]
    ds_read_b128 v[184:187], v244 offset:53248
    v_max_f32 v53, 0, v53
    buffer_load_dwordx4 a[120:123], v2, s[20:23], s39 offen offset:2048 sc1
    v_mfma_f32_16x16x32_bf16 v[68:71], a[172:175], v[152:155], v[68:71]
    v_max_f32 v54, 0, v54
    v_mfma_f32_16x16x32_bf16 v[72:75], a[176:179], v[152:155], v[72:75]
    v_max_f32 v55, 0, v55
    s_waitcnt lgkmcnt(7)
    v_mfma_f32_16x16x32_bf16 v[76:79], a[168:171], v[156:159], v[76:79]
    ds_read_b128 v[188:191], v244 offset:55296
    v_max_f32 v48, 0, v48
    v_mfma_f32_16x16x32_bf16 v[80:83], a[172:175], v[156:159], v[80:83]
    v_max_f32 v49, 0, v49
    buffer_load_dwordx4 a[124:127], v2, s[20:23], s39 offen offset:3072 sc1
    v_mfma_f32_16x16x32_bf16 v[84:87], a[176:179], v[156:159], v[84:87]
    v_max_f32 v50, 0, v50
    s_waitcnt lgkmcnt(7)
    v_mfma_f32_16x16x32_bf16 v[64:67], a[180:183], v[160:163], v[64:67]
    ds_read_b128 v[192:195], v245 offset:53248
    v_max_f32 v51, 0, v51
    v_mfma_f32_16x16x32_bf16 v[68:71], a[184:187], v[160:163], v[68:71]
    v_pk_mul_f32 v[40:41], v[40:41], v[44:45]
    v_mfma_f32_16x16x32_bf16 v[72:75], a[188:191], v[160:163], v[72:75]
    v_pk_mul_f32 v[42:43], v[42:43], v[46:47]
    s_mov_b32 s39, 45056
    buffer_load_dwordx4 a[128:131], v2, s[20:23], s39 offen offset:0 sc1
    s_waitcnt lgkmcnt(7)
    v_mfma_f32_16x16x32_bf16 v[76:79], a[180:183], v[164:167], v[76:79]
    ds_read_b128 v[196:199], v245 offset:55296
    v_cvt_pk_bf16_f32 v208, v40, v41
    v_mfma_f32_16x16x32_bf16 v[80:83], a[184:187], v[164:167], v[80:83]
    v_cvt_pk_bf16_f32 v209, v42, v43
    v_mfma_f32_16x16x32_bf16 v[84:87], a[188:191], v[164:167], v[84:87]
    v_pk_mul_f32 v[52:53], v[52:53], v[56:57]
    s_waitcnt vmcnt(14)
    s_mov_b32 s34, 16384
Lfh:
    v_xor_b32 v252, s8, v252
    v_xor_b32 v253, s9, v253
    v_or_b32 v252, v252, v253
    v_cmp_ne_u32 vcc, 0, v252
    s_nop 0
    s_cmp_eq_u64 vcc, 0
    s_cbranch_scc1 Lfh_x
    buffer_load_dwordx2 v[252:253], v243, s[16:19], s63 offen sc1
    s_waitcnt vmcnt(0)
    s_sub_u32 s34, s34, 1
    s_cbranch_scc0 Lfh
Lfh_x:
    s_waitcnt lgkmcnt(7)
    v_mfma_f32_16x16x32_bf16 v[64:67], a[192:195], v[168:171], v[64:67]
    ds_read_b128 v[136:139], v244 offset:8192
    v_pk_mul_f32 v[54:55], v[54:55], v[58:59]
    v_mfma_f32_16x16x32_bf16 v[68:71], a[196:199], v[168:171], v[68:71]
    v_cvt_pk_bf16_f32 v210, v52, v53
    v_mfma_f32_16x16x32_bf16 v[72:75], a[200:203], v[168:171], v[72:75]
    v_cvt_pk_bf16_f32 v211, v54, v55
    s_waitcnt lgkmcnt(7)
    v_mfma_f32_16x16x32_bf16 v[76:79], a[192:195], v[172:175], v[76:79]
    ds_read_b128 v[140:143], v244 offset:10240
    v_pk_mul_f32 v[48:49], v[48:49], v[60:61]
    v_mfma_f32_16x16x32_bf16 v[80:83], a[196:199], v[172:175], v[80:83]
    v_pk_mul_f32 v[50:51], v[50:51], v[62:63]
    v_mfma_f32_16x16x32_bf16 v[84:87], a[200:203], v[172:175], v[84:87]
    v_cvt_pk_bf16_f32 v212, v48, v49
    s_waitcnt lgkmcnt(7)
    v_mfma_f32_16x16x32_bf16 v[64:67], a[204:207], v[176:179], v[64:67]
    ds_read_b128 v[144:147], v245 offset:8192
    v_cvt_pk_bf16_f32 v213, v50, v51
    v_mfma_f32_16x16x32_bf16 v[68:71], a[208:211], v[176:179], v[68:71]
    v_permlane16_swap_b32 v208, v210
    v_mfma_f32_16x16x32_bf16 v[72:75], a[212:215], v[176:179], v[72:75]
    v_permlane16_swap_b32 v209, v211
    s_waitcnt lgkmcnt(7)
    v_mfma_f32_16x16x32_bf16 v[76:79], a[204:207], v[180:183], v[76:79]
    ds_read_b128 v[148:151], v245 offset:10240
    buffer_store_dwordx2 v[212:213], v235, s[16:19], s56 offen offset:512 sc1
    v_mfma_f32_16x16x32_bf16 v[80:83], a[208:211], v[180:183], v[80:83]
    buffer_store_dwordx4 v[208:211], v234, s[16:19], s56 offen sc1
    v_mfma_f32_16x16x32_bf16 v[84:87], a[212:215], v[180:183], v[84:87]
    s_waitcnt lgkmcnt(7)
    v_mfma_f32_16x16x32_bf16 v[64:67], a[216:219], v[184:187], v[64:67]
    ds_read_b128 v[152:155], v244 offset:24576
    v_mfma_f32_16x16x32_bf16 v[68:71], a[220:223], v[184:187], v[68:71]
    v_mfma_f32_16x16x32_bf16 v[72:75], a[224:227], v[184:187], v[72:75]
    s_waitcnt lgkmcnt(7)
    v_mfma_f32_16x16x32_bf16 v[76:79], a[216:219], v[188:191], v[76:79]
    ds_read_b128 v[156:159], v244 offset:26624
    v_mfma_f32_16x16x32_bf16 v[80:83], a[220:223], v[188:191], v[80:83]
    v_mfma_f32_16x16x32_bf16 v[84:87], a[224:227], v[188:191], v[84:87]
    s_waitcnt lgkmcnt(7)
    v_mfma_f32_16x16x32_bf16 v[64:67], a[228:231], v[192:195], v[64:67]
    ds_read_b128 v[160:163], v245 offset:24576
    v_mfma_f32_16x16x32_bf16 v[68:71], a[232:235], v[192:195], v[68:71]
    v_mfma_f32_16x16x32_bf16 v[72:75], a[236:239], v[192:195], v[72:75]
    s_waitcnt lgkmcnt(7)
    v_mfma_f32_16x16x32_bf16 v[76:79], a[228:231], v[196:199], v[76:79]
    ds_read_b128 v[164:167], v245 offset:26624
    v_mfma_f32_16x16x32_bf16 v[80:83], a[232:235], v[196:199], v[80:83]
    v_mfma_f32_16x16x32_bf16 v[84:87], a[236:239], v[196:199], v[84:87]
    s_waitcnt vmcnt(30)
    s_waitcnt lgkmcnt(7)
    v_mfma_f32_16x16x32_bf16 v[88:91], a[144:147], v[136:139], v[88:91]
    ds_read_b128 v[168:171], v244 offset:40960
    ds_read_b128 a[132:135], v236 offset:0
    v_mfma_f32_16x16x32_bf16 v[92:95], a[148:151], v[136:139], v[92:95]
    ds_read_b128 a[136:139], v236 offset:1024
    v_mfma_f32_16x16x32_bf16 v[96:99], a[152:155], v[136:139], v[96:99]
    ds_read_b128 a[140:143], v236 offset:2048
    s_waitcnt lgkmcnt(10)
    v_mfma_f32_16x16x32_bf16 v[100:103], a[144:147], v[140:143], v[100:103]
    ds_read_b128 v[172:175], v244 offset:43008
    v_permlane32_swap_b32 v72, v84
    v_mfma_f32_16x16x32_bf16 v[104:107], a[148:151], v[140:143], v[104:107]
    v_permlane32_swap_b32 v73, v85
    v_mfma_f32_16x16x32_bf16 v[108:111], a[152:155], v[140:143], v[108:111]
    v_permlane32_swap_b32 v74, v86
    s_waitcnt lgkmcnt(10)
    v_mfma_f32_16x16x32_bf16 v[88:91], a[156:159], v[144:147], v[88:91]
    ds_read_b128 v[176:179], v245 offset:40960
    v_permlane32_swap_b32 v75, v87
    v_mfma_f32_16x16x32_bf16 v[92:95], a[160:163], v[144:147], v[92:95]
    v_max_f32 v64, 0, v64
    v_mfma_f32_16x16x32_bf16 v[96:99], a[164:167], v[144:147], v[96:99]
    v_max_f32 v65, 0, v65
    s_waitcnt lgkmcnt(10)
    v_mfma_f32_16x16x32_bf16 v[100:103], a[156:159], v[148:151], v[100:103]
    ds_read_b128 v[180:183], v245 offset:43008
    v_max_f32 v66, 0, v66
    v_mfma_f32_16x16x32_bf16 v[104:107], a[160:163], v[148:151], v[104:107]
    v_max_f32 v67, 0, v67
    v_mfma_f32_16x16x32_bf16 v[108:111], a[164:167], v[148:151], v[108:111]
    v_max_f32 v76, 0, v76
    s_waitcnt lgkmcnt(10)
    v_mfma_f32_16x16x32_bf16 v[88:91], a[168:171], v[152:155], v[88:91]
    ds_read_b128 v[184:187], v244 offset:57344
    v_max_f32 v77, 0, v77
    v_mfma_f32_16x16x32_bf16 v[92:95], a[172:175], v[152:155], v[92:95]
    v_max_f32 v78, 0, v78
    v_mfma_f32_16x16x32_bf16 v[96:99], a[176:179], v[152:155], v[96:99]
    v_max_f32 v79, 0, v79
    s_waitcnt lgkmcnt(10)
    v_mfma_f32_16x16x32_bf16 v[100:103], a[168:171], v[156:159], v[100:103]
    ds_read_b128 v[188:191], v244 offset:59392
    v_max_f32 v72, 0, v72
    v_mfma_f32_16x16x32_bf16 v[104:107], a[172:175], v[156:159], v[104:107]
    v_max_f32 v73, 0, v73
    v_mfma_f32_16x16x32_bf16 v[108:111], a[176:179], v[156:159], v[108:111]
    v_max_f32 v74, 0, v74
    s_waitcnt lgkmcnt(10)
    v_mfma_f32_16x16x32_bf16 v[88:91], a[180:183], v[160:163], v[88:91]
    ds_read_b128 v[192:195], v245 offset:57344
    v_max_f32 v75, 0, v75
    v_mfma_f32_16x16x32_bf16 v[92:95], a[184:187], v[160:163], v[92:95]
    v_pk_mul_f32 v[64:65], v[64:65], v[68:69]
    v_mfma_f32_16x16x32_bf16 v[96:99], a[188:191], v[160:163], v[96:99]
    v_pk_mul_f32 v[66:67], v[66:67], v[70:71]
    s_waitcnt lgkmcnt(10)
    v_mfma_f32_16x16x32_bf16 v[100:103], a[180:183], v[164:167], v[100:103]
    ds_read_b128 v[196:199], v245 offset:59392
    v_cvt_pk_bf16_f32 v216, v64, v65
    v_mfma_f32_16x16x32_bf16 v[104:107], a[184:187], v[164:167], v[104:107]
    v_cvt_pk_bf16_f32 v217, v66, v67
    v_mfma_f32_16x16x32_bf16 v[108:111], a[188:191], v[164:167], v[108:111]
    v_pk_mul_f32 v[76:77], v[76:77], v[80:81]
    s_waitcnt lgkmcnt(10)
    v_mfma_f32_16x16x32_bf16 v[88:91], a[192:195], v[168:171], v[88:91]
    ds_read_b128 v[136:139], v244 offset:12288
    v_pk_mul_f32 v[78:79], v[78:79], v[82:83]
    v_mfma_f32_16x16x32_bf16 v[92:95], a[196:199], v[168:171], v[92:95]
    v_cvt_pk_bf16_f32 v218, v76, v77
    v_mfma_f32_16x16x32_bf16 v[96:99], a[200:203], v[168:171], v[96:99]
    v_cvt_pk_bf16_f32 v219, v78, v79
    s_waitcnt lgkmcnt(7)
    v_mfma_f32_16x16x32_bf16 v[100:103], a[192:195], v[172:175], v[100:103]
    ds_read_b128 v[140:143], v244 offset:14336
    v_pk_mul_f32 v[72:73], v[72:73], v[84:85]
    v_mfma_f32_16x16x32_bf16 v[104:107], a[196:199], v[172:175], v[104:107]
    v_pk_mul_f32 v[74:75], v[74:75], v[86:87]
    v_mfma_f32_16x16x32_bf16 v[108:111], a[200:203], v[172:175], v[108:111]
    v_cvt_pk_bf16_f32 v220, v72, v73
    s_waitcnt lgkmcnt(7)
    v_mfma_f32_16x16x32_bf16 v[88:91], a[204:207], v[176:179], v[88:91]
    ds_read_b128 v[144:147], v245 offset:12288
    v_cvt_pk_bf16_f32 v221, v74, v75
    v_mfma_f32_16x16x32_bf16 v[92:95], a[208:211], v[176:179], v[92:95]
    v_permlane16_swap_b32 v216, v218
    v_mfma_f32_16x16x32_bf16 v[96:99], a[212:215], v[176:179], v[96:99]
    v_permlane16_swap_b32 v217, v219
    s_waitcnt lgkmcnt(7)
    v_mfma_f32_16x16x32_bf16 v[100:103], a[204:207], v[180:183], v[100:103]
    ds_read_b128 v[148:151], v245 offset:14336
    buffer_store_dwordx2 v[220:221], v235, s[16:19], s57 offen offset:512 sc1
    v_mfma_f32_16x16x32_bf16 v[104:107], a[208:211], v[180:183], v[104:107]
    buffer_store_dwordx4 v[216:219], v234, s[16:19], s57 offen sc1
    v_mfma_f32_16x16x32_bf16 v[108:111], a[212:215], v[180:183], v[108:111]
    s_waitcnt lgkmcnt(7)
    v_mfma_f32_16x16x32_bf16 v[88:91], a[216:219], v[184:187], v[88:91]
    ds_read_b128 v[152:155], v244 offset:28672
    v_mfma_f32_16x16x32_bf16 v[92:95], a[220:223], v[184:187], v[92:95]
    v_mfma_f32_16x16x32_bf16 v[96:99], a[224:227], v[184:187], v[96:99]
    s_waitcnt lgkmcnt(7)
    v_mfma_f32_16x16x32_bf16 v[100:103], a[216:219], v[188:191], v[100:103]
    ds_read_b128 v[156:159], v244 offset:30720
    v_mfma_f32_16x16x32_bf16 v[104:107], a[220:223], v[188:191], v[104:107]
    v_mfma_f32_16x16x32_bf16 v[108:111], a[224:227], v[188:191], v[108:111]
    s_waitcnt lgkmcnt(7)
    v_mfma_f32_16x16x32_bf16 v[88:91], a[228:231], v[192:195], v[88:91]
    ds_read_b128 v[160:163], v245 offset:28672
    v_mfma_f32_16x16x32_bf16 v[92:95], a[232:235], v[192:195], v[92:95]
    v_mfma_f32_16x16x32_bf16 v[96:99], a[236:239], v[192:195], v[96:99]
    s_waitcnt lgkmcnt(7)
    v_mfma_f32_16x16x32_bf16 v[100:103], a[228:231], v[196:199], v[100:103]
    ds_read_b128 v[164:167], v245 offset:30720
    v_mfma_f32_16x16x32_bf16 v[104:107], a[232:235], v[196:199], v[104:107]
    v_mfma_f32_16x16x32_bf16 v[108:111], a[236:239], v[196:199], v[108:111]
    s_waitcnt lgkmcnt(7)
    v_mfma_f32_16x16x32_bf16 v[112:115], a[144:147], v[136:139], v[112:115]
    ds_read_b128 v[168:171], v244 offset:45056
    v_mfma_f32_16x16x32_bf16 v[116:119], a[148:151], v[136:139], v[116:119]
    v_mfma_f32_16x16x32_bf16 v[120:123], a[152:155], v[136:139], v[120:123]
    s_waitcnt lgkmcnt(7)
    v_mfma_f32_16x16x32_bf16 v[124:127], a[144:147], v[140:143], v[124:127]
    ds_read_b128 v[172:175], v244 offset:47104
    buffer_load_dwordx4 v[40:43], v2, s[16:19], s48 offen offset:0 sc1
    v_mfma_f32_16x16x32_bf16 v[128:131], a[148:151], v[140:143], v[128:131]
    v_mfma_f32_16x16x32_bf16 v[132:135], a[152:155], v[140:143], v[132:135]
    s_waitcnt lgkmcnt(7)
    v_mfma_f32_16x16x32_bf16 v[112:115], a[156:159], v[144:147], v[112:115]
    ds_read_b128 v[176:179], v245 offset:45056
    ds_read_b128 a[144:147], v236 offset:3072
    buffer_load_dwordx4 v[44:47], v2, s[16:19], s48 offen offset:1024 sc1
    v_mfma_f32_16x16x32_bf16 v[116:119], a[160:163], v[144:147], v[116:119]
    ds_read_b128 a[148:151], v236 offset:4096
    v_mfma_f32_16x16x32_bf16 v[120:123], a[164:167], v[144:147], v[120:123]
    ds_read_b128 a[152:155], v236 offset:5120
    s_waitcnt lgkmcnt(10)
    v_mfma_f32_16x16x32_bf16 v[124:127], a[156:159], v[148:151], v[124:127]
    ds_read_b128 v[180:183], v245 offset:47104
    buffer_load_dwordx4 v[48:51], v2, s[16:19], s48 offen offset:2048 sc1
    v_mfma_f32_16x16x32_bf16 v[128:131], a[160:163], v[148:151], v[128:131]
    v_mfma_f32_16x16x32_bf16 v[132:135], a[164:167], v[148:151], v[132:135]
    s_waitcnt lgkmcnt(10)
    v_mfma_f32_16x16x32_bf16 v[112:115], a[168:171], v[152:155], v[112:115]
    ds_read_b128 v[184:187], v244 offset:61440
    ds_read_b128 a[156:159], v236 offset:6144
    buffer_load_dwordx4 v[52:55], v2, s[16:19], s48 offen offset:3072 sc1
    v_mfma_f32_16x16x32_bf16 v[116:119], a[172:175], v[152:155], v[116:119]
    ds_read_b128 a[160:163], v236 offset:7168
    v_mfma_f32_16x16x32_bf16 v[120:123], a[176:179], v[152:155], v[120:123]
    ds_read_b128 a[164:167], v236 offset:8192
    s_waitcnt lgkmcnt(13)
    v_mfma_f32_16x16x32_bf16 v[124:127], a[168:171], v[156:159], v[124:127]
    ds_read_b128 v[188:191], v244 offset:63488
    v_permlane32_swap_b32 v96, v108
    buffer_load_dwordx4 v[56:59], v2, s[16:19], s49 offen offset:0 sc1
    v_mfma_f32_16x16x32_bf16 v[128:131], a[172:175], v[156:159], v[128:131]
    v_permlane32_swap_b32 v97, v109
    v_mfma_f32_16x16x32_bf16 v[132:135], a[176:179], v[156:159], v[132:135]
    v_permlane32_swap_b32 v98, v110
    s_waitcnt lgkmcnt(13)
    v_mfma_f32_16x16x32_bf16 v[112:115], a[180:183], v[160:163], v[112:115]
    ds_read_b128 v[192:195], v245 offset:61440
    ds_read_b128 a[168:171], v236 offset:9216
    ds_read_b128 a[172:175], v236 offset:10240
    buffer_load_dwordx4 v[60:63], v2, s[16:19], s49 offen offset:1024 sc1
    v_mfma_f32_16x16x32_bf16 v[116:119], a[184:187], v[160:163], v[116:119]
    ds_read_b128 a[176:179], v236 offset:11264
    v_permlane32_swap_b32 v99, v111
    v_mfma_f32_16x16x32_bf16 v[120:123], a[188:191], v[160:163], v[120:123]
    v_max_f32 v88, 0, v88
    v_max_f32 v89, 0, v89
    s_waitcnt lgkmcnt(15)
    v_mfma_f32_16x16x32_bf16 v[124:127], a[180:183], v[164:167], v[124:127]
    ds_read_b128 v[196:199], v245 offset:63488
    v_max_f32 v90, 0, v90
    buffer_load_dwordx4 v[64:67], v2, s[16:19], s49 offen offset:2048 sc1
    v_mfma_f32_16x16x32_bf16 v[128:131], a[184:187], v[164:167], v[128:131]
    v_max_f32 v91, 0, v91
    v_mfma_f32_16x16x32_bf16 v[132:135], a[188:191], v[164:167], v[132:135]
    v_max_f32 v100, 0, v100
    v_mfma_f32_16x16x32_bf16 v[112:115], a[192:195], v[168:171], v[112:115]
    ds_read_b128 a[180:183], v236 offset:12288
    ds_read_b128 a[184:187], v236 offset:13312
    buffer_load_dwordx4 v[68:71], v2, s[16:19], s49 offen offset:3072 sc1
    v_mfma_f32_16x16x32_bf16 v[116:119], a[196:199], v[168:171], v[116:119]
    ds_read_b128 a[188:191], v236 offset:14336
    v_max_f32 v101, 0, v101
    v_mfma_f32_16x16x32_bf16 v[120:123], a[200:203], v[168:171], v[120:123]
    v_max_f32 v102, 0, v102
    v_max_f32 v103, 0, v103
    s_waitcnt lgkmcnt(15)
    v_mfma_f32_16x16x32_bf16 v[124:127], a[192:195], v[172:175], v[124:127]
    v_max_f32 v96, 0, v96
    buffer_load_dwordx4 v[72:75], v2, s[16:19], s50 offen offset:0 sc1
    v_mfma_f32_16x16x32_bf16 v[128:131], a[196:199], v[172:175], v[128:131]
    v_max_f32 v97, 0, v97
    v_mfma_f32_16x16x32_bf16 v[132:135], a[200:203], v[172:175], v[132:135]
    v_max_f32 v98, 0, v98
    v_mfma_f32_16x16x32_bf16 v[112:115], a[204:207], v[176:179], v[112:115]
    v_max_f32 v99, 0, v99
    buffer_load_dwordx4 v[76:79], v2, s[16:19], s50 offen offset:1024 sc1
    v_mfma_f32_16x16x32_bf16 v[116:119], a[208:211], v[176:179], v[116:119]
    v_pk_mul_f32 v[88:89], v[88:89], v[92:93]
    v_mfma_f32_16x16x32_bf16 v[120:123], a[212:215], v[176:179], v[120:123]
    v_pk_mul_f32 v[90:91], v[90:91], v[94:95]
    s_waitcnt lgkmcnt(13)
    v_mfma_f32_16x16x32_bf16 v[124:127], a[204:207], v[180:183], v[124:127]
    v_cvt_pk_bf16_f32 v208, v88, v89
    buffer_load_dwordx4 v[80:83], v2, s[16:19], s50 offen offset:2048 sc1
    v_mfma_f32_16x16x32_bf16 v[128:131], a[208:211], v[180:183], v[128:131]
    v_cvt_pk_bf16_f32 v209, v90, v91
    v_mfma_f32_16x16x32_bf16 v[132:135], a[212:215], v[180:183], v[132:135]
    v_pk_mul_f32 v[100:101], v[100:101], v[104:105]
    s_waitcnt lgkmcnt(12)
    v_mfma_f32_16x16x32_bf16 v[112:115], a[216:219], v[184:187], v[112:115]
    v_pk_mul_f32 v[102:103], v[102:103], v[106:107]
    buffer_load_dwordx4 v[84:87], v2, s[16:19], s50 offen offset:3072 sc1
    v_mfma_f32_16x16x32_bf16 v[116:119], a[220:223], v[184:187], v[116:119]
    v_cvt_pk_bf16_f32 v210, v100, v101
    v_mfma_f32_16x16x32_bf16 v[120:123], a[224:227], v[184:187], v[120:123]
    v_cvt_pk_bf16_f32 v211, v102, v103
    s_waitcnt lgkmcnt(8)
    v_mfma_f32_16x16x32_bf16 v[124:127], a[216:219], v[188:191], v[124:127]
    v_pk_mul_f32 v[96:97], v[96:97], v[108:109]
    v_mfma_f32_16x16x32_bf16 v[128:131], a[220:223], v[188:191], v[128:131]
    v_pk_mul_f32 v[98:99], v[98:99], v[110:111]
    v_mfma_f32_16x16x32_bf16 v[132:135], a[224:227], v[188:191], v[132:135]
    v_cvt_pk_bf16_f32 v212, v96, v97
    s_waitcnt lgkmcnt(7)
    v_mfma_f32_16x16x32_bf16 v[112:115], a[228:231], v[192:195], v[112:115]
    v_cvt_pk_bf16_f32 v213, v98, v99
    v_mfma_f32_16x16x32_bf16 v[116:119], a[232:235], v[192:195], v[116:119]
    v_permlane16_swap_b32 v208, v210
    v_mfma_f32_16x16x32_bf16 v[120:123], a[236:239], v[192:195], v[120:123]
    v_permlane16_swap_b32 v209, v211
    s_waitcnt lgkmcnt(3)
    v_mfma_f32_16x16x32_bf16 v[124:127], a[228:231], v[196:199], v[124:127]
    buffer_store_dwordx2 v[212:213], v235, s[16:19], s58 offen offset:512 sc1
    v_mfma_f32_16x16x32_bf16 v[128:131], a[232:235], v[196:199], v[128:131]
    buffer_store_dwordx4 v[208:211], v234, s[16:19], s58 offen sc1
    v_mfma_f32_16x16x32_bf16 v[132:135], a[236:239], v[196:199], v[132:135]
    s_waitcnt vmcnt(11)
    v_max3_u32 v250, v40, v41, v42
    v_max3_u32 v250, v250, v43, v44
    v_max3_u32 v250, v250, v45, v46
    v_max3_u32 v250, v250, v47, v48
    v_max3_u32 v250, v250, v49, v50
    v_max_u32 v250, v250, v51
    v_cmp_eq_u32 vcc, -1, v250
    s_nop 0
    s_cmp_lg_u64 vcc, 0
    s_cbranch_scc1 Lre0_0
Lok0_0:
    s_waitcnt lgkmcnt(0)
    v_mfma_f32_16x16x32_bf16 v[184:187], a[240:243], v[40:43], 0
    v_permlane32_swap_b32 v120, v132
    v_permlane32_swap_b32 v121, v133
    v_mfma_f32_16x16x32_bf16 v[188:191], a[244:247], v[40:43], 0
    v_permlane32_swap_b32 v122, v134
    buffer_load_dwordx4 v[136:139], v226, s[16:19], s48 offen offset:0 sc1
    v_mfma_f32_16x16x32_bf16 v[192:195], a[248:251], v[40:43], 0
    v_permlane32_swap_b32 v123, v135
    v_mfma_f32_16x16x32_bf16 v[196:199], a[252:255], v[40:43], 0
    v_max_f32 v112, 0, v112
    v_mfma_f32_16x16x32_bf16 v[200:203], v[8:11], v[40:43], 0
    v_max_f32 v113, 0, v113
    buffer_load_dwordx4 v[140:143], v226, s[16:19], s48 offen offset:1024 sc1
    v_mfma_f32_16x16x32_bf16 v[184:187], v[12:15], v[44:47], v[184:187]
    v_max_f32 v114, 0, v114
    v_max_f32 v115, 0, v115
    v_max_f32 v124, 0, v124
    v_mfma_f32_16x16x32_bf16 v[188:191], v[16:19], v[44:47], v[188:191]
    v_max_f32 v125, 0, v125
    v_max_f32 v126, 0, v126
    v_mfma_f32_16x16x32_bf16 v[192:195], v[20:23], v[44:47], v[192:195]
    v_max_f32 v127, 0, v127
    s_waitcnt vmcnt(10)
    buffer_load_dwordx4 v[144:147], v226, s[16:19], s48 offen offset:2048 sc1
    v_mfma_f32_16x16x32_bf16 v[196:199], v[24:27], v[44:47], v[196:199]
    v_max3_u32 v250, v52, v53, v54
    v_max3_u32 v250, v250, v55, v56
    v_mfma_f32_16x16x32_bf16 v[200:203], v[28:31], v[44:47], v[200:203]
    v_max3_u32 v250, v250, v57, v58
    v_max3_u32 v250, v250, v59, v60
    v_mfma_f32_16x16x32_bf16 v[184:187], v[32:35], v[48:51], v[184:187]
    v_max_f32 v120, 0, v120
    v_max_f32 v121, 0, v121
    buffer_load_dwordx4 v[148:151], v226, s[16:19], s48 offen offset:3072 sc1
    v_mfma_f32_16x16x32_bf16 v[188:191], v[36:39], v[48:51], v[188:191]
    v_max_f32 v122, 0, v122
    v_max_f32 v123, 0, v123
    v_mfma_f32_16x16x32_bf16 v[192:195], a[0:3], v[48:51], v[192:195]
    v_pk_mul_f32 v[112:113], v[112:113], v[116:117]
    v_pk_mul_f32 v[114:115], v[114:115], v[118:119]
    v_mfma_f32_16x16x32_bf16 v[196:199], a[4:7], v[48:51], v[196:199]
    v_max3_u32 v250, v250, v61, v62
    v_max_u32 v250, v250, v63
    buffer_load_dwordx4 v[152:155], v226, s[16:19], s49 offen offset:0 sc1
    v_mfma_f32_16x16x32_bf16 v[200:203], a[8:11], v[48:51], v[200:203]
    v_cmp_eq_u32 vcc, -1, v250
    s_nop 0
    s_cmp_lg_u64 vcc, 0
    s_cbranch_scc1 Lre0_1
Lok0_1:
    v_mfma_f32_16x16x32_bf16 v[184:187], a[12:15], v[52:55], v[184:187]
    v_cvt_pk_bf16_f32 v216, v112, v113
    v_cvt_pk_bf16_f32 v217, v114, v115
    v_mfma_f32_16x16x32_bf16 v[188:191], a[16:19], v[52:55], v[188:191]
    v_pk_mul_f32 v[124:125], v[124:125], v[128:129]
    buffer_load_dwordx4 v[156:159], v226, s[16:19], s49 offen offset:1024 sc1
    v_mfma_f32_16x16x32_bf16 v[192:195], a[20:23], v[52:55], v[192:195]
    v_pk_mul_f32 v[126:127], v[126:127], v[130:131]
    v_mfma_f32_16x16x32_bf16 v[196:199], a[24:27], v[52:55], v[196:199]
    v_cvt_pk_bf16_f32 v218, v124, v125
    v_mfma_f32_16x16x32_bf16 v[200:203], a[28:31], v[52:55], v[200:203]
    v_cvt_pk_bf16_f32 v219, v126, v127
    buffer_load_dwordx4 v[160:163], v226, s[16:19], s49 offen offset:2048 sc1
    v_mfma_f32_16x16x32_bf16 v[184:187], a[32:35], v[56:59], v[184:187]
    v_pk_mul_f32 v[120:121], v[120:121], v[132:133]
    v_pk_mul_f32 v[122:123], v[122:123], v[134:135]
    v_cvt_pk_bf16_f32 v220, v120, v121
    v_mfma_f32_16x16x32_bf16 v[188:191], a[36:39], v[56:59], v[188:191]
    v_cvt_pk_bf16_f32 v221, v122, v123
    v_permlane16_swap_b32 v216, v218
    v_mfma_f32_16x16x32_bf16 v[192:195], a[40:43], v[56:59], v[192:195]
    v_permlane16_swap_b32 v217, v219
    s_waitcnt vmcnt(12)
    buffer_load_dwordx4 v[164:167], v226, s[16:19], s49 offen offset:3072 sc1
    v_mfma_f32_16x16x32_bf16 v[196:199], a[44:47], v[56:59], v[196:199]
    v_max3_u32 v250, v64, v65, v66
    v_max3_u32 v250, v250, v67, v68
    v_mfma_f32_16x16x32_bf16 v[200:203], a[48:51], v[56:59], v[200:203]
    v_max3_u32 v250, v250, v69, v70
    v_max3_u32 v250, v250, v71, v72
    v_mfma_f32_16x16x32_bf16 v[184:187], a[52:55], v[60:63], v[184:187]
    v_max3_u32 v250, v250, v73, v74
    buffer_load_dwordx4 v[168:171], v226, s[16:19], s50 offen offset:0 sc1
    v_mfma_f32_16x16x32_bf16 v[188:191], a[56:59], v[60:63], v[188:191]
    v_max_u32 v250, v250, v75
    v_mfma_f32_16x16x32_bf16 v[192:195], a[60:63], v[60:63], v[192:195]
    v_cmp_eq_u32 vcc, -1, v250
    v_mfma_f32_16x16x32_bf16 v[196:199], a[64:67], v[60:63], v[196:199]
    s_cmp_lg_u64 vcc, 0
    s_cbranch_scc1 Lre0_2
Lok0_2:
    buffer_load_dwordx4 v[172:175], v226, s[16:19], s50 offen offset:1024 sc1
    v_mfma_f32_16x16x32_bf16 v[200:203], a[68:71], v[60:63], v[200:203]
    buffer_load_dwordx4 v[176:179], v226, s[16:19], s50 offen offset:2048 sc1
    buffer_load_dwordx4 v[180:183], v226, s[16:19], s50 offen offset:3072 sc1
    v_mfma_f32_16x16x32_bf16 v[184:187], a[72:75], v[64:67], v[184:187]
    buffer_store_dwordx2 v[220:221], v235, s[16:19], s59 offen offset:512 sc1
    buffer_store_dwordx4 v[216:219], v234, s[16:19], s59 offen sc1
    v_mfma_f32_16x16x32_bf16 v[188:191], a[76:79], v[64:67], v[188:191]
    v_lshrrev_b32 v232, 4, v1
    v_mfma_f32_16x16x32_bf16 v[192:195], a[80:83], v[64:67], v[192:195]
    v_and_b32 v233, 15, v1
    v_mfma_f32_16x16x32_bf16 v[196:199], a[84:87], v[64:67], v[196:199]
    v_mul_u32_u24 v229, 1280, v233
    v_mfma_f32_16x16x32_bf16 v[200:203], a[88:91], v[64:67], v[200:203]
    v_lshl_add_u32 v230, v232, 5, v229
    v_mfma_f32_16x16x32_bf16 v[184:187], a[92:95], v[68:71], v[184:187]
    v_lshl_add_u32 v229, v232, 4, v229
    v_mul_u32_u24 v232, 80, v232
    v_mfma_f32_16x16x32_bf16 v[188:191], a[96:99], v[68:71], v[188:191]
    s_mul_i32 s63, s15, 320
    s_add_u32 s63, s63, 161280
    v_mfma_f32_16x16x32_bf16 v[192:195], a[100:103], v[68:71], v[192:195]
    s_waitcnt vmcnt(16)
    v_max3_u32 v250, v76, v77, v78
    v_mfma_f32_16x16x32_bf16 v[196:199], a[104:107], v[68:71], v[196:199]
    v_max3_u32 v250, v250, v79, v80
    v_max3_u32 v250, v250, v81, v82
    v_mfma_f32_16x16x32_bf16 v[200:203], a[108:111], v[68:71], v[200:203]
    v_max3_u32 v250, v250, v83, v84
    v_mfma_f32_16x16x32_bf16 v[184:187], a[112:115], v[72:75], v[184:187]
    v_add_u32 v231, s63, v232
    v_and_b32 v237, 7, v1
    v_mfma_f32_16x16x32_bf16 v[188:191], a[116:119], v[72:75], v[188:191]
    v_lshlrev_b32 v237, 8, v237
    v_bfe_u32 v238, v1, 3, 1
    v_mfma_f32_16x16x32_bf16 v[192:195], a[120:123], v[72:75], v[192:195]
    v_max3_u32 v250, v250, v85, v86
    v_max_u32 v250, v250, v87
    v_mfma_f32_16x16x32_bf16 v[196:199], a[124:127], v[72:75], v[196:199]
    v_cmp_eq_u32 vcc, -1, v250
    v_mfma_f32_16x16x32_bf16 v[200:203], a[128:131], v[72:75], v[200:203]
    s_cmp_lg_u64 vcc, 0
    s_cbranch_scc1 Lre0_3
Lok0_3:
    v_mfma_f32_16x16x32_bf16 v[184:187], a[132:135], v[76:79], v[184:187]
    v_add3_u32 v237, v237, v238, s60
    v_mul_u32_u24 v237, 1280, v237
    v_mfma_f32_16x16x32_bf16 v[188:191], a[136:139], v[76:79], v[188:191]
    v_lshrrev_b32 v232, 1, v232
    s_mul_i32 s63, s15, 160
    v_mfma_f32_16x16x32_bf16 v[192:195], a[140:143], v[76:79], v[192:195]
    s_waitcnt vmcnt(8)
    v_max3_u32 v250, v136, v137, v138
    v_mfma_f32_16x16x32_bf16 v[196:199], a[144:147], v[76:79], v[196:199]
    v_max3_u32 v250, v250, v139, v140
    v_max3_u32 v250, v250, v141, v142
    v_mfma_f32_16x16x32_bf16 v[200:203], a[148:151], v[76:79], v[200:203]
    v_max3_u32 v250, v250, v143, v144
    v_mfma_f32_16x16x32_bf16 v[184:187], a[152:155], v[80:83], v[184:187]
    v_add3_u32 v237, v237, v232, s63
    s_mul_i32 s63, s3, 5120
    v_mfma_f32_16x16x32_bf16 v[188:191], a[156:159], v[80:83], v[188:191]
    s_add_u32 s63, s63, 62720
    v_add_u32 v238, s63, v2
    v_mfma_f32_16x16x32_bf16 v[192:195], a[160:163], v[80:83], v[192:195]
    v_max3_u32 v250, v250, v145, v146
    v_max3_u32 v250, v250, v147, v148
    v_mfma_f32_16x16x32_bf16 v[196:199], a[164:167], v[80:83], v[196:199]
    v_max3_u32 v250, v250, v149, v150
    v_max3_u32 v250, v250, v151, v152
    v_mfma_f32_16x16x32_bf16 v[200:203], a[168:171], v[80:83], v[200:203]
    v_max3_u32 v250, v250, v153, v154
    v_mfma_f32_16x16x32_bf16 v[184:187], a[172:175], v[84:87], v[184:187]
    v_add_u32 v239, 40960, v238
    s_mul_i32 s63, s3, 20480
    v_mfma_f32_16x16x32_bf16 v[188:191], a[176:179], v[84:87], v[188:191]
    s_add_u32 s63, s63, 62720
    v_add_u32 v240, s63, v2
    v_mfma_f32_16x16x32_bf16 v[192:195], a[180:183], v[84:87], v[192:195]
    v_max3_u32 v250, v250, v155, v156
    v_max3_u32 v250, v250, v157, v158
    v_mfma_f32_16x16x32_bf16 v[196:199], a[184:187], v[84:87], v[196:199]
    v_max_u32 v250, v250, v159
    v_cmp_eq_u32 vcc, -1, v250
    v_mfma_f32_16x16x32_bf16 v[200:203], a[188:191], v[84:87], v[200:203]
    s_cmp_lg_u64 vcc, 0
    s_cbranch_scc1 Lre1_0
Lok1_0:
    s_barrier
    v_mfma_f32_16x16x32_bf16 v[204:207], a[240:243], v[136:139], 0
    buffer_load_dwordx4 v[88:91], v227, s[16:19], s48 offen offset:0 sc1
    v_mfma_f32_16x16x32_bf16 v[208:211], a[244:247], v[136:139], 0
    v_mfma_f32_16x16x32_bf16 v[212:215], a[248:251], v[136:139], 0
    v_mfma_f32_16x16x32_bf16 v[216:219], a[252:255], v[136:139], 0
    buffer_load_dwordx4 v[92:95], v227, s[16:19], s48 offen offset:1024 sc1
    v_mfma_f32_16x16x32_bf16 v[220:223], v[8:11], v[136:139], 0
    v_mfma_f32_16x16x32_bf16 v[204:207], v[12:15], v[140:143], v[204:207]
    v_mfma_f32_16x16x32_bf16 v[208:211], v[16:19], v[140:143], v[208:211]
    buffer_load_dwordx4 v[96:99], v227, s[16:19], s48 offen offset:2048 sc1
    v_mfma_f32_16x16x32_bf16 v[212:215], v[20:23], v[140:143], v[212:215]
    v_mfma_f32_16x16x32_bf16 v[216:219], v[24:27], v[140:143], v[216:219]
    v_mfma_f32_16x16x32_bf16 v[220:223], v[28:31], v[140:143], v[220:223]
    buffer_load_dwordx4 v[100:103], v227, s[16:19], s48 offen offset:3072 sc1
    buffer_load_dwordx4 v[104:107], v227, s[16:19], s49 offen offset:0 sc1
    buffer_load_dwordx4 v[108:111], v227, s[16:19], s49 offen offset:1024 sc1
    v_mfma_f32_16x16x32_bf16 v[204:207], v[32:35], v[144:147], v[204:207]
    ds_write_b128 v238, v[184:187] offset:0
    v_mfma_f32_16x16x32_bf16 v[208:211], v[36:39], v[144:147], v[208:211]
    v_mfma_f32_16x16x32_bf16 v[212:215], a[0:3], v[144:147], v[212:215]
    buffer_load_dwordx4 v[112:115], v227, s[16:19], s49 offen offset:2048 sc1
    v_mfma_f32_16x16x32_bf16 v[216:219], a[4:7], v[144:147], v[216:219]
    v_mfma_f32_16x16x32_bf16 v[220:223], a[8:11], v[144:147], v[220:223]
    v_mfma_f32_16x16x32_bf16 v[204:207], a[12:15], v[148:151], v[204:207]
    s_waitcnt vmcnt(9)
    v_max3_u32 v250, v160, v161, v162
    buffer_load_dwordx4 v[116:119], v227, s[16:19], s49 offen offset:3072 sc1
    v_mfma_f32_16x16x32_bf16 v[208:211], a[16:19], v[148:151], v[208:211]
    v_max3_u32 v250, v250, v163, v164
    v_mfma_f32_16x16x32_bf16 v[212:215], a[20:23], v[148:151], v[212:215]
    v_max3_u32 v250, v250, v165, v166
    v_mfma_f32_16x16x32_bf16 v[216:219], a[24:27], v[148:151], v[216:219]
    v_max3_u32 v250, v250, v167, v168
    buffer_load_dwordx4 v[120:123], v227, s[16:19], s50 offen offset:0 sc1
    v_mfma_f32_16x16x32_bf16 v[220:223], a[28:31], v[148:151], v[220:223]
    ds_write_b128 v238, v[188:191] offset:1024
    v_mfma_f32_16x16x32_bf16 v[204:207], a[32:35], v[152:155], v[204:207]
    v_max3_u32 v250, v250, v169, v170
    v_max3_u32 v250, v250, v171, v172
    v_mfma_f32_16x16x32_bf16 v[208:211], a[36:39], v[152:155], v[208:211]
    v_max3_u32 v250, v250, v173, v174
    buffer_load_dwordx4 v[124:127], v227, s[16:19], s50 offen offset:1024 sc1
    v_mfma_f32_16x16x32_bf16 v[212:215], a[40:43], v[152:155], v[212:215]
    v_max3_u32 v250, v250, v175, v176
    v_mfma_f32_16x16x32_bf16 v[216:219], a[44:47], v[152:155], v[216:219]
    v_max3_u32 v250, v250, v177, v178
    v_mfma_f32_16x16x32_bf16 v[220:223], a[48:51], v[152:155], v[220:223]
    ds_write_b128 v238, v[192:195] offset:2048
    buffer_load_dwordx4 v[128:131], v227, s[16:19], s50 offen offset:2048 sc1
    v_mfma_f32_16x16x32_bf16 v[204:207], a[52:55], v[156:159], v[204:207]
    v_max3_u32 v250, v250, v179, v180
    v_max3_u32 v250, v250, v181, v182
    v_mfma_f32_16x16x32_bf16 v[208:211], a[56:59], v[156:159], v[208:211]
    v_max_u32 v250, v250, v183
    v_mfma_f32_16x16x32_bf16 v[212:215], a[60:63], v[156:159], v[212:215]
    v_cmp_eq_u32 vcc, -1, v250
    buffer_load_dwordx4 v[132:135], v227, s[16:19], s50 offen offset:3072 sc1
    v_mfma_f32_16x16x32_bf16 v[216:219], a[64:67], v[156:159], v[216:219]
    s_cmp_lg_u64 vcc, 0
    s_cbranch_scc1 Lre1_1
Lok1_1:
    v_mfma_f32_16x16x32_bf16 v[220:223], a[68:71], v[156:159], v[220:223]
    ds_write_b128 v238, v[196:199] offset:3072
    v_mfma_f32_16x16x32_bf16 v[204:207], a[72:75], v[160:163], v[204:207]
    ds_write_b128 v238, v[200:203] offset:4096
    v_mfma_f32_16x16x32_bf16 v[208:211], a[76:79], v[160:163], v[208:211]
    v_mfma_f32_16x16x32_bf16 v[212:215], a[80:83], v[160:163], v[212:215]
    v_mfma_f32_16x16x32_bf16 v[216:219], a[84:87], v[160:163], v[216:219]
    v_mfma_f32_16x16x32_bf16 v[220:223], a[88:91], v[160:163], v[220:223]
    v_mfma_f32_16x16x32_bf16 v[204:207], a[92:95], v[164:167], v[204:207]
    v_mfma_f32_16x16x32_bf16 v[208:211], a[96:99], v[164:167], v[208:211]
    v_mfma_f32_16x16x32_bf16 v[212:215], a[100:103], v[164:167], v[212:215]
    v_mfma_f32_16x16x32_bf16 v[216:219], a[104:107], v[164:167], v[216:219]
    v_mfma_f32_16x16x32_bf16 v[220:223], a[108:111], v[164:167], v[220:223]
    v_mfma_f32_16x16x32_bf16 v[204:207], a[112:115], v[168:171], v[204:207]
    v_mfma_f32_16x16x32_bf16 v[208:211], a[116:119], v[168:171], v[208:211]
    v_mfma_f32_16x16x32_bf16 v[212:215], a[120:123], v[168:171], v[212:215]
    v_mfma_f32_16x16x32_bf16 v[216:219], a[124:127], v[168:171], v[216:219]
    v_mfma_f32_16x16x32_bf16 v[220:223], a[128:131], v[168:171], v[220:223]
    v_mfma_f32_16x16x32_bf16 v[204:207], a[132:135], v[172:175], v[204:207]
    s_waitcnt vmcnt(6)
    v_mfma_f32_16x16x32_bf16 v[208:211], a[136:139], v[172:175], v[208:211]
    v_max3_u32 v250, v88, v89, v90
    v_mfma_f32_16x16x32_bf16 v[212:215], a[140:143], v[172:175], v[212:215]
    v_max3_u32 v250, v250, v91, v92
    v_mfma_f32_16x16x32_bf16 v[216:219], a[144:147], v[172:175], v[216:219]
    v_max3_u32 v250, v250, v93, v94
    v_mfma_f32_16x16x32_bf16 v[220:223], a[148:151], v[172:175], v[220:223]
    v_max3_u32 v250, v250, v95, v96
    v_mfma_f32_16x16x32_bf16 v[204:207], a[152:155], v[176:179], v[204:207]
    v_max3_u32 v250, v250, v97, v98
    buffer_load_dwordx4 v[40:43], v228, s[16:19], s48 offen offset:0 sc1
    v_mfma_f32_16x16x32_bf16 v[208:211], a[156:159], v[176:179], v[208:211]
    v_max3_u32 v250, v250, v99, v100
    v_mfma_f32_16x16x32_bf16 v[212:215], a[160:163], v[176:179], v[212:215]
    v_max3_u32 v250, v250, v101, v102
    v_mfma_f32_16x16x32_bf16 v[216:219], a[164:167], v[176:179], v[216:219]
    v_max3_u32 v250, v250, v103, v104
    buffer_load_dwordx4 v[44:47], v228, s[16:19], s48 offen offset:1024 sc1
    v_mfma_f32_16x16x32_bf16 v[220:223], a[168:171], v[176:179], v[220:223]
    v_max3_u32 v250, v250, v105, v106
    v_mfma_f32_16x16x32_bf16 v[204:207], a[172:175], v[180:183], v[204:207]
    v_max3_u32 v250, v250, v107, v108
    v_mfma_f32_16x16x32_bf16 v[208:211], a[176:179], v[180:183], v[208:211]
    v_max3_u32 v250, v250, v109, v110
    buffer_load_dwordx4 v[48:51], v228, s[16:19], s48 offen offset:2048 sc1
    v_mfma_f32_16x16x32_bf16 v[212:215], a[180:183], v[180:183], v[212:215]
    v_max_u32 v250, v250, v111
    v_mfma_f32_16x16x32_bf16 v[216:219], a[184:187], v[180:183], v[216:219]
    v_cmp_eq_u32 vcc, -1, v250
    v_mfma_f32_16x16x32_bf16 v[220:223], a[188:191], v[180:183], v[220:223]
    s_cmp_lg_u64 vcc, 0
    s_cbranch_scc1 Lre2_0
Lok2_0:
    buffer_load_dwordx4 v[52:55], v228, s[16:19], s48 offen offset:3072 sc1
    v_mfma_f32_16x16x32_bf16 v[184:187], a[240:243], v[88:91], 0
    v_mfma_f32_16x16x32_bf16 v[188:191], a[244:247], v[88:91], 0
    v_mfma_f32_16x16x32_bf16 v[192:195], a[248:251], v[88:91], 0
    buffer_load_dwordx4 v[56:59], v228, s[16:19], s49 offen offset:0 sc1
    v_mfma_f32_16x16x32_bf16 v[196:199], a[252:255], v[88:91], 0
    v_mfma_f32_16x16x32_bf16 v[200:203], v[8:11], v[88:91], 0
    v_mfma_f32_16x16x32_bf16 v[184:187], v[12:15], v[92:95], v[184:187]
    buffer_load_dwordx4 v[60:63], v228, s[16:19], s49 offen offset:1024 sc1
    v_mfma_f32_16x16x32_bf16 v[188:191], v[16:19], v[92:95], v[188:191]
    v_mfma_f32_16x16x32_bf16 v[192:195], v[20:23], v[92:95], v[192:195]
    v_mfma_f32_16x16x32_bf16 v[196:199], v[24:27], v[92:95], v[196:199]
    buffer_load_dwordx4 v[64:67], v228, s[16:19], s49 offen offset:2048 sc1
    v_mfma_f32_16x16x32_bf16 v[200:203], v[28:31], v[92:95], v[200:203]
    v_mfma_f32_16x16x32_bf16 v[184:187], v[32:35], v[96:99], v[184:187]
    ds_write_b128 v238, v[204:207] offset:20480
    v_mfma_f32_16x16x32_bf16 v[188:191], v[36:39], v[96:99], v[188:191]
    buffer_load_dwordx4 v[68:71], v228, s[16:19], s49 offen offset:3072 sc1
    v_mfma_f32_16x16x32_bf16 v[192:195], a[0:3], v[96:99], v[192:195]
    v_mfma_f32_16x16x32_bf16 v[196:199], a[4:7], v[96:99], v[196:199]
    v_mfma_f32_16x16x32_bf16 v[200:203], a[8:11], v[96:99], v[200:203]
    buffer_load_dwordx4 v[72:75], v228, s[16:19], s50 offen offset:0 sc1
    v_mfma_f32_16x16x32_bf16 v[184:187], a[12:15], v[100:103], v[184:187]
    s_waitcnt vmcnt(9)
    v_max3_u32 v250, v112, v113, v114
    v_mfma_f32_16x16x32_bf16 v[188:191], a[16:19], v[100:103], v[188:191]
    v_max3_u32 v250, v250, v115, v116
    v_mfma_f32_16x16x32_bf16 v[192:195], a[20:23], v[100:103], v[192:195]
    v_max3_u32 v250, v250, v117, v118
    buffer_load_dwordx4 v[76:79], v228, s[16:19], s50 offen offset:1024 sc1
    v_mfma_f32_16x16x32_bf16 v[196:199], a[24:27], v[100:103], v[196:199]
    v_max3_u32 v250, v250, v119, v120
    v_mfma_f32_16x16x32_bf16 v[200:203], a[28:31], v[100:103], v[200:203]
    ds_write_b128 v238, v[208:211] offset:21504
    v_mfma_f32_16x16x32_bf16 v[184:187], a[32:35], v[104:107], v[184:187]
    v_max3_u32 v250, v250, v121, v122
    v_max3_u32 v250, v250, v123, v124
    buffer_load_dwordx4 v[80:83], v228, s[16:19], s50 offen offset:2048 sc1
    v_mfma_f32_16x16x32_bf16 v[188:191], a[36:39], v[104:107], v[188:191]
    v_max3_u32 v250, v250, v125, v126
    v_mfma_f32_16x16x32_bf16 v[192:195], a[40:43], v[104:107], v[192:195]
    v_max3_u32 v250, v250, v127, v128
    v_mfma_f32_16x16x32_bf16 v[196:199], a[44:47], v[104:107], v[196:199]
    v_max3_u32 v250, v250, v129, v130
    buffer_load_dwordx4 v[84:87], v228, s[16:19], s50 offen offset:3072 sc1
    v_mfma_f32_16x16x32_bf16 v[200:203], a[48:51], v[104:107], v[200:203]
    ds_write_b128 v238, v[212:215] offset:22528
    v_mfma_f32_16x16x32_bf16 v[184:187], a[52:55], v[108:111], v[184:187]
    v_max3_u32 v250, v250, v131, v132
    v_max3_u32 v250, v250, v133, v134
    v_mfma_f32_16x16x32_bf16 v[188:191], a[56:59], v[108:111], v[188:191]
    v_max_u32 v250, v250, v135
    buffer_load_dwordx4 v[136:139], v230, s[16:19], s61 offen sc1
    v_mfma_f32_16x16x32_bf16 v[192:195], a[60:63], v[108:111], v[192:195]
    v_cmp_eq_u32 vcc, -1, v250
    v_mfma_f32_16x16x32_bf16 v[196:199], a[64:67], v[108:111], v[196:199]
    s_cmp_lg_u64 vcc, 0
    s_cbranch_scc1 Lre2_1
Lok2_1:
    v_mfma_f32_16x16x32_bf16 v[200:203], a[68:71], v[108:111], v[200:203]
    ds_write_b128 v238, v[216:219] offset:23552
    buffer_load_dwordx4 v[140:143], v230, s[16:19], s61 offen offset:16 sc1
    v_mfma_f32_16x16x32_bf16 v[184:187], a[72:75], v[112:115], v[184:187]
    ds_write_b128 v238, v[220:223] offset:24576
    v_mfma_f32_16x16x32_bf16 v[188:191], a[76:79], v[112:115], v[188:191]
    v_mfma_f32_16x16x32_bf16 v[192:195], a[80:83], v[112:115], v[192:195]
    buffer_load_dwordx2 v[144:145], v229, s[16:19], s62 offen offset:1024 sc1
    v_mfma_f32_16x16x32_bf16 v[196:199], a[84:87], v[112:115], v[196:199]
    v_mfma_f32_16x16x32_bf16 v[200:203], a[88:91], v[112:115], v[200:203]
    v_mfma_f32_16x16x32_bf16 v[184:187], a[92:95], v[116:119], v[184:187]
    v_mfma_f32_16x16x32_bf16 v[188:191], a[96:99], v[116:119], v[188:191]
    v_mfma_f32_16x16x32_bf16 v[192:195], a[100:103], v[116:119], v[192:195]
    v_mfma_f32_16x16x32_bf16 v[196:199], a[104:107], v[116:119], v[196:199]
    v_mfma_f32_16x16x32_bf16 v[200:203], a[108:111], v[116:119], v[200:203]
    v_mfma_f32_16x16x32_bf16 v[184:187], a[112:115], v[120:123], v[184:187]
    v_mfma_f32_16x16x32_bf16 v[188:191], a[116:119], v[120:123], v[188:191]
    v_mfma_f32_16x16x32_bf16 v[192:195], a[120:123], v[120:123], v[192:195]
    v_mfma_f32_16x16x32_bf16 v[196:199], a[124:127], v[120:123], v[196:199]
    v_mfma_f32_16x16x32_bf16 v[200:203], a[128:131], v[120:123], v[200:203]
    v_mfma_f32_16x16x32_bf16 v[184:187], a[132:135], v[124:127], v[184:187]
    s_waitcnt vmcnt(9)
    v_mfma_f32_16x16x32_bf16 v[188:191], a[136:139], v[124:127], v[188:191]
    v_max3_u32 v250, v40, v41, v42
    v_mfma_f32_16x16x32_bf16 v[192:195], a[140:143], v[124:127], v[192:195]
    v_max3_u32 v250, v250, v43, v44
    v_mfma_f32_16x16x32_bf16 v[196:199], a[144:147], v[124:127], v[196:199]
    v_max3_u32 v250, v250, v45, v46
    v_mfma_f32_16x16x32_bf16 v[200:203], a[148:151], v[124:127], v[200:203]
    v_max3_u32 v250, v250, v47, v48
    v_mfma_f32_16x16x32_bf16 v[184:187], a[152:155], v[128:131], v[184:187]
    v_max3_u32 v250, v250, v49, v50
    v_mfma_f32_16x16x32_bf16 v[188:191], a[156:159], v[128:131], v[188:191]
    v_max3_u32 v250, v250, v51, v52
    v_mfma_f32_16x16x32_bf16 v[192:195], a[160:163], v[128:131], v[192:195]
    v_max3_u32 v250, v250, v53, v54
    v_mfma_f32_16x16x32_bf16 v[196:199], a[164:167], v[128:131], v[196:199]
    v_max3_u32 v250, v250, v55, v56
    v_mfma_f32_16x16x32_bf16 v[200:203], a[168:171], v[128:131], v[200:203]
    v_max3_u32 v250, v250, v57, v58
    v_mfma_f32_16x16x32_bf16 v[184:187], a[172:175], v[132:135], v[184:187]
    v_max3_u32 v250, v250, v59, v60
    v_mfma_f32_16x16x32_bf16 v[188:191], a[176:179], v[132:135], v[188:191]
    v_max3_u32 v250, v250, v61, v62
    v_mfma_f32_16x16x32_bf16 v[192:195], a[180:183], v[132:135], v[192:195]
    v_max_u32 v250, v250, v63
    v_mfma_f32_16x16x32_bf16 v[196:199], a[184:187], v[132:135], v[196:199]
    v_cmp_eq_u32 vcc, -1, v250
    v_mfma_f32_16x16x32_bf16 v[200:203], a[188:191], v[132:135], v[200:203]
    s_cmp_lg_u64 vcc, 0
    s_cbranch_scc1 Lre3_0
Lok3_0:
    v_mfma_f32_16x16x32_bf16 v[204:207], a[240:243], v[40:43], 0
    v_mfma_f32_16x16x32_bf16 v[208:211], a[244:247], v[40:43], 0
    v_mfma_f32_16x16x32_bf16 v[212:215], a[248:251], v[40:43], 0
    v_mfma_f32_16x16x32_bf16 v[216:219], a[252:255], v[40:43], 0
    v_mfma_f32_16x16x32_bf16 v[220:223], v[8:11], v[40:43], 0
    v_mfma_f32_16x16x32_bf16 v[204:207], v[12:15], v[44:47], v[204:207]
    v_mfma_f32_16x16x32_bf16 v[208:211], v[16:19], v[44:47], v[208:211]
    v_mfma_f32_16x16x32_bf16 v[212:215], v[20:23], v[44:47], v[212:215]
    v_mfma_f32_16x16x32_bf16 v[216:219], v[24:27], v[44:47], v[216:219]
    v_mfma_f32_16x16x32_bf16 v[220:223], v[28:31], v[44:47], v[220:223]
    v_mfma_f32_16x16x32_bf16 v[204:207], v[32:35], v[48:51], v[204:207]
    ds_write_b128 v239, v[184:187] offset:0
    v_mfma_f32_16x16x32_bf16 v[208:211], v[36:39], v[48:51], v[208:211]
    v_mfma_f32_16x16x32_bf16 v[212:215], a[0:3], v[48:51], v[212:215]
    v_mfma_f32_16x16x32_bf16 v[216:219], a[4:7], v[48:51], v[216:219]
    v_mfma_f32_16x16x32_bf16 v[220:223], a[8:11], v[48:51], v[220:223]
    v_mfma_f32_16x16x32_bf16 v[204:207], a[12:15], v[52:55], v[204:207]
    s_waitcnt vmcnt(3)
    v_max3_u32 v250, v64, v65, v66
    v_mfma_f32_16x16x32_bf16 v[208:211], a[16:19], v[52:55], v[208:211]
    v_max3_u32 v250, v250, v67, v68
    v_mfma_f32_16x16x32_bf16 v[212:215], a[20:23], v[52:55], v[212:215]
    v_max3_u32 v250, v250, v69, v70
    v_mfma_f32_16x16x32_bf16 v[216:219], a[24:27], v[52:55], v[216:219]
    v_max3_u32 v250, v250, v71, v72
    v_mfma_f32_16x16x32_bf16 v[220:223], a[28:31], v[52:55], v[220:223]
    ds_write_b128 v239, v[188:191] offset:1024
    v_mfma_f32_16x16x32_bf16 v[204:207], a[32:35], v[56:59], v[204:207]
    v_max3_u32 v250, v250, v73, v74
    v_max3_u32 v250, v250, v75, v76
    v_mfma_f32_16x16x32_bf16 v[208:211], a[36:39], v[56:59], v[208:211]
    v_max3_u32 v250, v250, v77, v78
    v_mfma_f32_16x16x32_bf16 v[212:215], a[40:43], v[56:59], v[212:215]
    v_max3_u32 v250, v250, v79, v80
    v_mfma_f32_16x16x32_bf16 v[216:219], a[44:47], v[56:59], v[216:219]
    v_max3_u32 v250, v250, v81, v82
    v_mfma_f32_16x16x32_bf16 v[220:223], a[48:51], v[56:59], v[220:223]
    ds_write_b128 v239, v[192:195] offset:2048
    v_mfma_f32_16x16x32_bf16 v[204:207], a[52:55], v[60:63], v[204:207]
    v_max3_u32 v250, v250, v83, v84
    v_max3_u32 v250, v250, v85, v86
    v_mfma_f32_16x16x32_bf16 v[208:211], a[56:59], v[60:63], v[208:211]
    v_max_u32 v250, v250, v87
    v_mfma_f32_16x16x32_bf16 v[212:215], a[60:63], v[60:63], v[212:215]
    v_cmp_eq_u32 vcc, -1, v250
    v_mfma_f32_16x16x32_bf16 v[216:219], a[64:67], v[60:63], v[216:219]
    s_cmp_lg_u64 vcc, 0
    s_cbranch_scc1 Lre3_1
Lok3_1:
    v_mfma_f32_16x16x32_bf16 v[220:223], a[68:71], v[60:63], v[220:223]
    ds_write_b128 v239, v[196:199] offset:3072
    v_mfma_f32_16x16x32_bf16 v[204:207], a[72:75], v[64:67], v[204:207]
    ds_write_b128 v239, v[200:203] offset:4096
    v_mfma_f32_16x16x32_bf16 v[208:211], a[76:79], v[64:67], v[208:211]
    ds_read_b128 v[148:151], v231 offset:0
    v_mfma_f32_16x16x32_bf16 v[212:215], a[80:83], v[64:67], v[212:215]
    v_mfma_f32_16x16x32_bf16 v[216:219], a[84:87], v[64:67], v[216:219]
    v_mfma_f32_16x16x32_bf16 v[220:223], a[88:91], v[64:67], v[220:223]
    v_mfma_f32_16x16x32_bf16 v[204:207], a[92:95], v[68:71], v[204:207]
    ds_read_b128 v[152:155], v231 offset:16
    v_mfma_f32_16x16x32_bf16 v[208:211], a[96:99], v[68:71], v[208:211]
    v_mfma_f32_16x16x32_bf16 v[212:215], a[100:103], v[68:71], v[212:215]
    v_mfma_f32_16x16x32_bf16 v[216:219], a[104:107], v[68:71], v[216:219]
    v_mfma_f32_16x16x32_bf16 v[220:223], a[108:111], v[68:71], v[220:223]
    v_mfma_f32_16x16x32_bf16 v[204:207], a[112:115], v[72:75], v[204:207]
    ds_read_b128 v[156:159], v231 offset:32
    v_mfma_f32_16x16x32_bf16 v[208:211], a[116:119], v[72:75], v[208:211]
    v_mfma_f32_16x16x32_bf16 v[212:215], a[120:123], v[72:75], v[212:215]
    v_mfma_f32_16x16x32_bf16 v[216:219], a[124:127], v[72:75], v[216:219]
    v_mfma_f32_16x16x32_bf16 v[220:223], a[128:131], v[72:75], v[220:223]
    v_mfma_f32_16x16x32_bf16 v[204:207], a[132:135], v[76:79], v[204:207]
    ds_read_b128 v[160:163], v231 offset:48
    v_mfma_f32_16x16x32_bf16 v[208:211], a[136:139], v[76:79], v[208:211]
    v_mfma_f32_16x16x32_bf16 v[212:215], a[140:143], v[76:79], v[212:215]
    v_mfma_f32_16x16x32_bf16 v[216:219], a[144:147], v[76:79], v[216:219]
    v_mfma_f32_16x16x32_bf16 v[220:223], a[148:151], v[76:79], v[220:223]
    v_mfma_f32_16x16x32_bf16 v[204:207], a[152:155], v[80:83], v[204:207]
    ds_read_b128 v[164:167], v231 offset:64
    v_mfma_f32_16x16x32_bf16 v[208:211], a[156:159], v[80:83], v[208:211]
    v_mfma_f32_16x16x32_bf16 v[212:215], a[160:163], v[80:83], v[212:215]
    v_mfma_f32_16x16x32_bf16 v[216:219], a[164:167], v[80:83], v[216:219]
    v_mfma_f32_16x16x32_bf16 v[220:223], a[168:171], v[80:83], v[220:223]
    v_mfma_f32_16x16x32_bf16 v[204:207], a[172:175], v[84:87], v[204:207]
    v_mfma_f32_16x16x32_bf16 v[208:211], a[176:179], v[84:87], v[208:211]
    v_mfma_f32_16x16x32_bf16 v[212:215], a[180:183], v[84:87], v[212:215]
    v_mfma_f32_16x16x32_bf16 v[216:219], a[184:187], v[84:87], v[216:219]
    v_mfma_f32_16x16x32_bf16 v[220:223], a[188:191], v[84:87], v[220:223]
    s_waitcnt vmcnt(0)
    v_lshlrev_b32 v184, 16, v136
    v_and_b32 v185, s13, v136
    v_lshlrev_b32 v186, 16, v137
    v_and_b32 v187, s13, v137
    v_lshlrev_b32 v188, 16, v138
    v_and_b32 v189, s13, v138
    v_lshlrev_b32 v190, 16, v139
    v_and_b32 v191, s13, v139
    ds_write_b128 v239, v[204:207] offset:20480
    ds_write_b128 v239, v[208:211] offset:21504
    ds_write_b128 v239, v[212:215] offset:22528
    ds_write_b128 v239, v[216:219] offset:23552
    ds_write_b128 v239, v[220:223] offset:24576
    v_lshlrev_b32 v192, 16, v144
    v_and_b32 v193, s13, v144
    v_lshlrev_b32 v194, 16, v140
    v_and_b32 v195, s13, v140
    v_lshlrev_b32 v196, 16, v141
    v_and_b32 v197, s13, v141
    v_lshlrev_b32 v198, 16, v142
    v_and_b32 v199, s13, v142
    v_lshlrev_b32 v200, 16, v143
    v_and_b32 v201, s13, v143
    v_lshlrev_b32 v202, 16, v145
    v_and_b32 v203, s13, v145
    s_waitcnt lgkmcnt(0)
    s_barrier
    ds_read_b128 v[40:43], v240 offset:0
    ds_read_b128 v[44:47], v240 offset:1024
    ds_read_b128 v[48:51], v240 offset:2048
    ds_read_b128 v[52:55], v240 offset:3072
    ds_read_b128 v[56:59], v240 offset:4096
    ds_read_b128 v[60:63], v240 offset:5120
    ds_read_b128 v[64:67], v240 offset:6144
    ds_read_b128 v[68:71], v240 offset:7168
    ds_read_b128 v[72:75], v240 offset:8192
    ds_read_b128 v[76:79], v240 offset:9216
    ds_read_b128 v[80:83], v240 offset:10240
    ds_read_b128 v[84:87], v240 offset:11264
    ds_read_b128 v[88:91], v240 offset:12288
    ds_read_b128 v[92:95], v240 offset:13312
    ds_read_b128 v[96:99], v240 offset:14336
    ds_read_b128 v[100:103], v240 offset:15360
    ds_read_b128 v[104:107], v240 offset:16384
    ds_read_b128 v[108:111], v240 offset:17408
    ds_read_b128 v[112:115], v240 offset:18432
    ds_read_b128 v[116:119], v240 offset:19456
    s_waitcnt lgkmcnt(10)
    v_pk_add_f32 v[40:41], v[40:41], v[60:61]
    v_pk_add_f32 v[42:43], v[42:43], v[62:63]
    v_pk_add_f32 v[44:45], v[44:45], v[64:65]
    v_pk_add_f32 v[46:47], v[46:47], v[66:67]
    v_pk_add_f32 v[48:49], v[48:49], v[68:69]
    v_pk_add_f32 v[50:51], v[50:51], v[70:71]
    v_pk_add_f32 v[52:53], v[52:53], v[72:73]
    v_pk_add_f32 v[54:55], v[54:55], v[74:75]
    v_pk_add_f32 v[56:57], v[56:57], v[76:77]
    v_pk_add_f32 v[58:59], v[58:59], v[78:79]
    s_waitcnt lgkmcnt(0)
    v_pk_add_f32 v[80:81], v[80:81], v[100:101]
    v_pk_add_f32 v[82:83], v[82:83], v[102:103]
    v_pk_add_f32 v[84:85], v[84:85], v[104:105]
    v_pk_add_f32 v[86:87], v[86:87], v[106:107]
    v_pk_add_f32 v[88:89], v[88:89], v[108:109]
    v_pk_add_f32 v[90:91], v[90:91], v[110:111]
    v_pk_add_f32 v[92:93], v[92:93], v[112:113]
    v_pk_add_f32 v[94:95], v[94:95], v[114:115]
    v_pk_add_f32 v[96:97], v[96:97], v[116:117]
    v_pk_add_f32 v[98:99], v[98:99], v[118:119]
    v_pk_add_f32 v[40:41], v[40:41], v[80:81]
    v_pk_add_f32 v[42:43], v[42:43], v[82:83]
    v_pk_add_f32 v[44:45], v[44:45], v[84:85]
    v_pk_add_f32 v[46:47], v[46:47], v[86:87]
    v_pk_add_f32 v[48:49], v[48:49], v[88:89]
    v_pk_add_f32 v[50:51], v[50:51], v[90:91]
    v_pk_add_f32 v[52:53], v[52:53], v[92:93]
    v_pk_add_f32 v[54:55], v[54:55], v[94:95]
    v_pk_add_f32 v[56:57], v[56:57], v[96:97]
    v_pk_add_f32 v[58:59], v[58:59], v[98:99]
    v_pk_fma_f32 v[184:185], v[40:41], v[148:149], v[184:185]
    v_pk_fma_f32 v[186:187], v[42:43], v[150:151], v[186:187]
    v_pk_fma_f32 v[188:189], v[44:45], v[152:153], v[188:189]
    v_pk_fma_f32 v[190:191], v[46:47], v[154:155], v[190:191]
    v_pk_fma_f32 v[192:193], v[48:49], v[156:157], v[192:193]
    v_pk_fma_f32 v[194:195], v[50:51], v[158:159], v[194:195]
    v_pk_fma_f32 v[196:197], v[52:53], v[160:161], v[196:197]
    v_pk_fma_f32 v[198:199], v[54:55], v[162:163], v[198:199]
    v_pk_fma_f32 v[200:201], v[56:57], v[164:165], v[200:201]
    v_pk_fma_f32 v[202:203], v[58:59], v[166:167], v[202:203]
    v_cvt_pk_bf16_f32 v136, v184, v185
    v_cvt_pk_bf16_f32 v137, v186, v187
    v_cvt_pk_bf16_f32 v138, v188, v189
    v_cvt_pk_bf16_f32 v139, v190, v191
    v_cvt_pk_bf16_f32 v140, v192, v193
    v_cvt_pk_bf16_f32 v141, v194, v195
    v_cvt_pk_bf16_f32 v142, v196, v197
    v_cvt_pk_bf16_f32 v143, v198, v199
    v_cvt_pk_bf16_f32 v144, v200, v201
    v_cvt_pk_bf16_f32 v145, v202, v203
    buffer_store_dwordx4 v[136:139], v237, s[24:27], 0 offen
    buffer_store_dwordx4 v[140:143], v237, s[24:27], 0 offen offset:16
    buffer_store_dwordx2 v[144:145], v237, s[24:27], 0 offen offset:32
Lm_end:
    s_endpgm
Lre0_0:
    s_mov_b32 s34, 16384
Lpr0_0:
    buffer_load_dwordx4 v[40:43], v2, s[16:19], s48 offen offset:0 sc1
    buffer_load_dwordx4 v[44:47], v2, s[16:19], s48 offen offset:1024 sc1
    buffer_load_dwordx4 v[48:51], v2, s[16:19], s48 offen offset:2048 sc1
    buffer_load_dwordx4 v[52:55], v2, s[16:19], s48 offen offset:3072 sc1
    buffer_load_dwordx4 v[56:59], v2, s[16:19], s49 offen offset:0 sc1
    buffer_load_dwordx4 v[60:63], v2, s[16:19], s49 offen offset:1024 sc1
    buffer_load_dwordx4 v[64:67], v2, s[16:19], s49 offen offset:2048 sc1
    buffer_load_dwordx4 v[68:71], v2, s[16:19], s49 offen offset:3072 sc1
    buffer_load_dwordx4 v[72:75], v2, s[16:19], s50 offen offset:0 sc1
    buffer_load_dwordx4 v[76:79], v2, s[16:19], s50 offen offset:1024 sc1
    buffer_load_dwordx4 v[80:83], v2, s[16:19], s50 offen offset:2048 sc1
    buffer_load_dwordx4 v[84:87], v2, s[16:19], s50 offen offset:3072 sc1
    s_waitcnt vmcnt(0)
    v_max3_u32 v250, v40, v41, v42
    v_max3_u32 v250, v250, v43, v44
    v_max3_u32 v250, v250, v45, v46
    v_max3_u32 v250, v250, v47, v48
    v_max3_u32 v250, v250, v49, v50
    v_max_u32 v250, v250, v51
    v_cmp_eq_u32 vcc, -1, v250
    s_sub_u32 s34, s34, 1
    s_cbranch_scc1 Lpr0_0_x
    s_cmp_lg_u64 vcc, 0
    s_cbranch_scc1 Lpr0_0
Lpr0_0_x:
    s_branch Lok0_0
Lre0_1:
    s_mov_b32 s34, 16384
Lpr0_1:
    buffer_load_dwordx4 v[52:55], v2, s[16:19], s48 offen offset:3072 sc1
    buffer_load_dwordx4 v[56:59], v2, s[16:19], s49 offen offset:0 sc1
    buffer_load_dwordx4 v[60:63], v2, s[16:19], s49 offen offset:1024 sc1
    buffer_load_dwordx4 v[64:67], v2, s[16:19], s49 offen offset:2048 sc1
    buffer_load_dwordx4 v[68:71], v2, s[16:19], s49 offen offset:3072 sc1
    buffer_load_dwordx4 v[72:75], v2, s[16:19], s50 offen offset:0 sc1
    buffer_load_dwordx4 v[76:79], v2, s[16:19], s50 offen offset:1024 sc1
    buffer_load_dwordx4 v[80:83], v2, s[16:19], s50 offen offset:2048 sc1
    buffer_load_dwordx4 v[84:87], v2, s[16:19], s50 offen offset:3072 sc1
    s_waitcnt vmcnt(0)
    v_max3_u32 v250, v52, v53, v54
    v_max3_u32 v250, v250, v55, v56
    v_max3_u32 v250, v250, v57, v58
    v_max3_u32 v250, v250, v59, v60
    v_max3_u32 v250, v250, v61, v62
    v_max_u32 v250, v250, v63
    v_cmp_eq_u32 vcc, -1, v250
    s_sub_u32 s34, s34, 1
    s_cbranch_scc1 Lpr0_1_x
    s_cmp_lg_u64 vcc, 0
    s_cbranch_scc1 Lpr0_1
Lpr0_1_x:
    s_branch Lok0_1
Lre0_2:
    s_mov_b32 s34, 16384
Lpr0_2:
    buffer_load_dwordx4 v[64:67], v2, s[16:19], s49 offen offset:2048 sc1
    buffer_load_dwordx4 v[68:71], v2, s[16:19], s49 offen offset:3072 sc1
    buffer_load_dwordx4 v[72:75], v2, s[16:19], s50 offen offset:0 sc1
    buffer_load_dwordx4 v[76:79], v2, s[16:19], s50 offen offset:1024 sc1
    buffer_load_dwordx4 v[80:83], v2, s[16:19], s50 offen offset:2048 sc1
    buffer_load_dwordx4 v[84:87], v2, s[16:19], s50 offen offset:3072 sc1
    s_waitcnt vmcnt(0)
    v_max3_u32 v250, v64, v65, v66
    v_max3_u32 v250, v250, v67, v68
    v_max3_u32 v250, v250, v69, v70
    v_max3_u32 v250, v250, v71, v72
    v_max3_u32 v250, v250, v73, v74
    v_max_u32 v250, v250, v75
    v_cmp_eq_u32 vcc, -1, v250
    s_sub_u32 s34, s34, 1
    s_cbranch_scc1 Lpr0_2_x
    s_cmp_lg_u64 vcc, 0
    s_cbranch_scc1 Lpr0_2
Lpr0_2_x:
    s_branch Lok0_2
Lre0_3:
    s_mov_b32 s34, 16384
Lpr0_3:
    buffer_load_dwordx4 v[76:79], v2, s[16:19], s50 offen offset:1024 sc1
    buffer_load_dwordx4 v[80:83], v2, s[16:19], s50 offen offset:2048 sc1
    buffer_load_dwordx4 v[84:87], v2, s[16:19], s50 offen offset:3072 sc1
    s_waitcnt vmcnt(0)
    v_max3_u32 v250, v76, v77, v78
    v_max3_u32 v250, v250, v79, v80
    v_max3_u32 v250, v250, v81, v82
    v_max3_u32 v250, v250, v83, v84
    v_max3_u32 v250, v250, v85, v86
    v_max_u32 v250, v250, v87
    v_cmp_eq_u32 vcc, -1, v250
    s_sub_u32 s34, s34, 1
    s_cbranch_scc1 Lpr0_3_x
    s_cmp_lg_u64 vcc, 0
    s_cbranch_scc1 Lpr0_3
Lpr0_3_x:
    s_branch Lok0_3
Lre1_0:
    s_mov_b32 s34, 16384
Lpr1_0:
    buffer_load_dwordx4 v[136:139], v226, s[16:19], s48 offen offset:0 sc1
    buffer_load_dwordx4 v[140:143], v226, s[16:19], s48 offen offset:1024 sc1
    buffer_load_dwordx4 v[144:147], v226, s[16:19], s48 offen offset:2048 sc1
    buffer_load_dwordx4 v[148:151], v226, s[16:19], s48 offen offset:3072 sc1
    buffer_load_dwordx4 v[152:155], v226, s[16:19], s49 offen offset:0 sc1
    buffer_load_dwordx4 v[156:159], v226, s[16:19], s49 offen offset:1024 sc1
    buffer_load_dwordx4 v[160:163], v226, s[16:19], s49 offen offset:2048 sc1
    buffer_load_dwordx4 v[164:167], v226, s[16:19], s49 offen offset:3072 sc1
    buffer_load_dwordx4 v[168:171], v226, s[16:19], s50 offen offset:0 sc1
    buffer_load_dwordx4 v[172:175], v226, s[16:19], s50 offen offset:1024 sc1
    buffer_load_dwordx4 v[176:179], v226, s[16:19], s50 offen offset:2048 sc1
    buffer_load_dwordx4 v[180:183], v226, s[16:19], s50 offen offset:3072 sc1
    s_waitcnt vmcnt(0)
    v_max3_u32 v250, v136, v137, v138
    v_max3_u32 v250, v250, v139, v140
    v_max3_u32 v250, v250, v141, v142
    v_max3_u32 v250, v250, v143, v144
    v_max3_u32 v250, v250, v145, v146
    v_max3_u32 v250, v250, v147, v148
    v_max3_u32 v250, v250, v149, v150
    v_max3_u32 v250, v250, v151, v152
    v_max3_u32 v250, v250, v153, v154
    v_max3_u32 v250, v250, v155, v156
    v_max3_u32 v250, v250, v157, v158
    v_max_u32 v250, v250, v159
    v_cmp_eq_u32 vcc, -1, v250
    s_sub_u32 s34, s34, 1
    s_cbranch_scc1 Lpr1_0_x
    s_cmp_lg_u64 vcc, 0
    s_cbranch_scc1 Lpr1_0
Lpr1_0_x:
    s_branch Lok1_0
Lre1_1:
    s_mov_b32 s34, 16384
Lpr1_1:
    buffer_load_dwordx4 v[160:163], v226, s[16:19], s49 offen offset:2048 sc1
    buffer_load_dwordx4 v[164:167], v226, s[16:19], s49 offen offset:3072 sc1
    buffer_load_dwordx4 v[168:171], v226, s[16:19], s50 offen offset:0 sc1
    buffer_load_dwordx4 v[172:175], v226, s[16:19], s50 offen offset:1024 sc1
    buffer_load_dwordx4 v[176:179], v226, s[16:19], s50 offen offset:2048 sc1
    buffer_load_dwordx4 v[180:183], v226, s[16:19], s50 offen offset:3072 sc1
    s_waitcnt vmcnt(0)
    v_max3_u32 v250, v160, v161, v162
    v_max3_u32 v250, v250, v163, v164
    v_max3_u32 v250, v250, v165, v166
    v_max3_u32 v250, v250, v167, v168
    v_max3_u32 v250, v250, v169, v170
    v_max3_u32 v250, v250, v171, v172
    v_max3_u32 v250, v250, v173, v174
    v_max3_u32 v250, v250, v175, v176
    v_max3_u32 v250, v250, v177, v178
    v_max3_u32 v250, v250, v179, v180
    v_max3_u32 v250, v250, v181, v182
    v_max_u32 v250, v250, v183
    v_cmp_eq_u32 vcc, -1, v250
    s_sub_u32 s34, s34, 1
    s_cbranch_scc1 Lpr1_1_x
    s_cmp_lg_u64 vcc, 0
    s_cbranch_scc1 Lpr1_1
Lpr1_1_x:
    s_branch Lok1_1
Lre2_0:
    s_mov_b32 s34, 16384
Lpr2_0:
    buffer_load_dwordx4 v[88:91], v227, s[16:19], s48 offen offset:0 sc1
    buffer_load_dwordx4 v[92:95], v227, s[16:19], s48 offen offset:1024 sc1
    buffer_load_dwordx4 v[96:99], v227, s[16:19], s48 offen offset:2048 sc1
    buffer_load_dwordx4 v[100:103], v227, s[16:19], s48 offen offset:3072 sc1
    buffer_load_dwordx4 v[104:107], v227, s[16:19], s49 offen offset:0 sc1
    buffer_load_dwordx4 v[108:111], v227, s[16:19], s49 offen offset:1024 sc1
    buffer_load_dwordx4 v[112:115], v227, s[16:19], s49 offen offset:2048 sc1
    buffer_load_dwordx4 v[116:119], v227, s[16:19], s49 offen offset:3072 sc1
    buffer_load_dwordx4 v[120:123], v227, s[16:19], s50 offen offset:0 sc1
    buffer_load_dwordx4 v[124:127], v227, s[16:19], s50 offen offset:1024 sc1
    buffer_load_dwordx4 v[128:131], v227, s[16:19], s50 offen offset:2048 sc1
    buffer_load_dwordx4 v[132:135], v227, s[16:19], s50 offen offset:3072 sc1
    s_waitcnt vmcnt(0)
    v_max3_u32 v250, v88, v89, v90
    v_max3_u32 v250, v250, v91, v92
    v_max3_u32 v250, v250, v93, v94
    v_max3_u32 v250, v250, v95, v96
    v_max3_u32 v250, v250, v97, v98
    v_max3_u32 v250, v250, v99, v100
    v_max3_u32 v250, v250, v101, v102
    v_max3_u32 v250, v250, v103, v104
    v_max3_u32 v250, v250, v105, v106
    v_max3_u32 v250, v250, v107, v108
    v_max3_u32 v250, v250, v109, v110
    v_max_u32 v250, v250, v111
    v_cmp_eq_u32 vcc, -1, v250
    s_sub_u32 s34, s34, 1
    s_cbranch_scc1 Lpr2_0_x
    s_cmp_lg_u64 vcc, 0
    s_cbranch_scc1 Lpr2_0
Lpr2_0_x:
    s_branch Lok2_0
Lre2_1:
    s_mov_b32 s34, 16384
Lpr2_1:
    buffer_load_dwordx4 v[112:115], v227, s[16:19], s49 offen offset:2048 sc1
    buffer_load_dwordx4 v[116:119], v227, s[16:19], s49 offen offset:3072 sc1
    buffer_load_dwordx4 v[120:123], v227, s[16:19], s50 offen offset:0 sc1
    buffer_load_dwordx4 v[124:127], v227, s[16:19], s50 offen offset:1024 sc1
    buffer_load_dwordx4 v[128:131], v227, s[16:19], s50 offen offset:2048 sc1
    buffer_load_dwordx4 v[132:135], v227, s[16:19], s50 offen offset:3072 sc1
    s_waitcnt vmcnt(0)
    v_max3_u32 v250, v112, v113, v114
    v_max3_u32 v250, v250, v115, v116
    v_max3_u32 v250, v250, v117, v118
    v_max3_u32 v250, v250, v119, v120
    v_max3_u32 v250, v250, v121, v122
    v_max3_u32 v250, v250, v123, v124
    v_max3_u32 v250, v250, v125, v126
    v_max3_u32 v250, v250, v127, v128
    v_max3_u32 v250, v250, v129, v130
    v_max3_u32 v250, v250, v131, v132
    v_max3_u32 v250, v250, v133, v134
    v_max_u32 v250, v250, v135
    v_cmp_eq_u32 vcc, -1, v250
    s_sub_u32 s34, s34, 1
    s_cbranch_scc1 Lpr2_1_x
    s_cmp_lg_u64 vcc, 0
    s_cbranch_scc1 Lpr2_1
Lpr2_1_x:
    s_branch Lok2_1
Lre3_0:
    s_mov_b32 s34, 16384
Lpr3_0:
    buffer_load_dwordx4 v[40:43], v228, s[16:19], s48 offen offset:0 sc1
    buffer_load_dwordx4 v[44:47], v228, s[16:19], s48 offen offset:1024 sc1
    buffer_load_dwordx4 v[48:51], v228, s[16:19], s48 offen offset:2048 sc1
    buffer_load_dwordx4 v[52:55], v228, s[16:19], s48 offen offset:3072 sc1
    buffer_load_dwordx4 v[56:59], v228, s[16:19], s49 offen offset:0 sc1
    buffer_load_dwordx4 v[60:63], v228, s[16:19], s49 offen offset:1024 sc1
    buffer_load_dwordx4 v[64:67], v228, s[16:19], s49 offen offset:2048 sc1
    buffer_load_dwordx4 v[68:71], v228, s[16:19], s49 offen offset:3072 sc1
    buffer_load_dwordx4 v[72:75], v228, s[16:19], s50 offen offset:0 sc1
    buffer_load_dwordx4 v[76:79], v228, s[16:19], s50 offen offset:1024 sc1
    buffer_load_dwordx4 v[80:83], v228, s[16:19], s50 offen offset:2048 sc1
    buffer_load_dwordx4 v[84:87], v228, s[16:19], s50 offen offset:3072 sc1
    s_waitcnt vmcnt(0)
    v_max3_u32 v250, v40, v41, v42
    v_max3_u32 v250, v250, v43, v44
    v_max3_u32 v250, v250, v45, v46
    v_max3_u32 v250, v250, v47, v48
    v_max3_u32 v250, v250, v49, v50
    v_max3_u32 v250, v250, v51, v52
    v_max3_u32 v250, v250, v53, v54
    v_max3_u32 v250, v250, v55, v56
    v_max3_u32 v250, v250, v57, v58
    v_max3_u32 v250, v250, v59, v60
    v_max3_u32 v250, v250, v61, v62
    v_max_u32 v250, v250, v63
    v_cmp_eq_u32 vcc, -1, v250
    s_sub_u32 s34, s34, 1
    s_cbranch_scc1 Lpr3_0_x
    s_cmp_lg_u64 vcc, 0
    s_cbranch_scc1 Lpr3_0
Lpr3_0_x:
    s_branch Lok3_0
Lre3_1:
    s_mov_b32 s34, 16384
Lpr3_1:
    buffer_load_dwordx4 v[64:67], v228, s[16:19], s49 offen offset:2048 sc1
    buffer_load_dwordx4 v[68:71], v228, s[16:19], s49 offen offset:3072 sc1
    buffer_load_dwordx4 v[72:75], v228, s[16:19], s50 offen offset:0 sc1
    buffer_load_dwordx4 v[76:79], v228, s[16:19], s50 offen offset:1024 sc1
    buffer_load_dwordx4 v[80:83], v228, s[16:19], s50 offen offset:2048 sc1
    buffer_load_dwordx4 v[84:87], v228, s[16:19], s50 offen offset:3072 sc1
    s_waitcnt vmcnt(0)
    v_max3_u32 v250, v64, v65, v66
    v_max3_u32 v250, v250, v67, v68
    v_max3_u32 v250, v250, v69, v70
    v_max3_u32 v250, v250, v71, v72
    v_max3_u32 v250, v250, v73, v74
    v_max3_u32 v250, v250, v75, v76
    v_max3_u32 v250, v250, v77, v78
    v_max3_u32 v250, v250, v79, v80
    v_max3_u32 v250, v250, v81, v82
    v_max3_u32 v250, v250, v83, v84
    v_max3_u32 v250, v250, v85, v86
    v_max_u32 v250, v250, v87
    v_cmp_eq_u32 vcc, -1, v250
    s_sub_u32 s34, s34, 1
    s_cbranch_scc1 Lpr3_1_x
    s_cmp_lg_u64 vcc, 0
    s_cbranch_scc1 Lpr3_1
Lpr3_1_x:
    s_branch Lok3_1
Lcode_end:
.section .rodata,"a"
.p2align 6
.amdhsa_kernel adaLN_cond__spectral_gfnet__glu_gated_reglu__prompt_kernel
  .amdhsa_next_free_vgpr 512
  .amdhsa_next_free_sgpr 64
  .amdhsa_accum_offset 256
  .amdhsa_group_segment_fixed_size 0
  .amdhsa_kernarg_size 96
  .amdhsa_user_sgpr_count 2
  .amdhsa_user_sgpr_kernarg_segment_ptr 1
  .amdhsa_system_sgpr_workgroup_id_x 1
.end_amdhsa_kernel
```
